```python
import torch

def _softmax(x, axis=-1):
    return torch.softmax(x, dim=axis)

def _gelu(x):
    return torch.nn.functional.gelu(x, approximate='tanh')

def _silu(x):
    return torch.nn.functional.silu(x)

def _sigmoid(x):
    return torch.sigmoid(x)

def _layernorm(x, axis=-1, eps=1e-05):
    m = x.mean(dim=axis, keepdim=True)
    v = x.var(dim=axis, keepdim=True, unbiased=False)
    return (x - m) / torch.sqrt(v + eps)

def _scatter_add(tgt, idx, src, axis=0):
    return tgt.clone().index_add_(axis, idx, src)

def _segment_sum(src, seg, n):
    out = torch.zeros((n,) + src.shape[1:], dtype=src.dtype)
    return out.index_add_(0, seg, src)

def _pad(x, pw):
    flat = tuple((v for pair in reversed(pw) for v in pair))
    return torch.nn.functional.pad(x, flat)
kernel_name = 'parallel_sum__softmax_full_mha__mixer_gmlp__prompt'

def setup_inputs():

    _w = lambda a: (lambda t: t.to(torch.bfloat16) if t.is_floating_point() else t)(torch.as_tensor(a))

    def _A_setup():
        B, S, D = (1, 2048, 448)
        return {'x': _w((lambda *s: torch.randn(*s, dtype=torch.bfloat16) * 0.05)(B, S, D)), 'wqkv': _w((lambda *s: torch.randn(*s, dtype=torch.bfloat16) * 0.2)(D, 3 * D)), 'wo': _w((lambda *s: torch.randn(*s, dtype=torch.bfloat16) * 0.1)(D, D))}
    _A_in = _A_setup()

    def _B_setup():
        B, S, D, F = (1, 2048, 448, 1792)
        Fh = F // 2
        return {'x': _w((lambda *s: torch.randn(*s, dtype=torch.bfloat16) * 0.05)(B, S, D)), 'w_in': _w((lambda *s: torch.randn(*s, dtype=torch.bfloat16) * 0.4)(D, 2 * Fh)), 'w_sp': _w(0.01 * (lambda *s: torch.randn(*s, dtype=torch.bfloat16) * 0.4)(S, S)), 'b_sp': _w(1.0 + 0.01 * (lambda *s: torch.randn(*s, dtype=torch.bfloat16) * 0.2)(S)), 'w_out': _w((lambda *s: torch.randn(*s, dtype=torch.bfloat16) * 0.2)(Fh, D))}
    _B_in = _B_setup()
    return {'A_x': _A_in['x'], 'A_wqkv': _A_in['wqkv'], 'A_wo': _A_in['wo'], 'B_x': _B_in['x'], 'B_w_in': _B_in['w_in'], 'B_w_sp': _B_in['w_sp'], 'B_b_sp': _B_in['b_sp'], 'B_w_out': _B_in['w_out']}

def reference(A_x, A_wqkv, A_wo, B_x, B_w_in, B_w_sp, B_b_sp, B_w_out):

    def _A_ref(x, wqkv, wo):
        B, S, D = x.shape
        H = 16
        Dh = D // H
        qkv = (lambda x, *d: x.permute(*d))((x @ wqkv).reshape(B, S, 3, H, Dh), 2, 0, 3, 1, 4)
        q, k, v = (qkv[0], qkv[1], qkv[2])
        scale = Dh ** (-0.5)
        scores = torch.einsum('bhqd,bhkd->bhqk', q, k) * scale
        p = _softmax(scores, axis=-1)
        o = torch.einsum('bhqk,bhkd->bhqd', p, v)
        return (lambda x, *d: x.permute(*d))(o, 0, 2, 1, 3).reshape(B, S, D) @ wo

    def _B_ref(x, w_in, w_sp, b_sp, w_out):
        B, S, D = x.shape
        F = w_in.shape[-1]
        Fh = F // 2
        z = _gelu(torch.einsum('bsd,df->bsf', x, w_in))
        z1 = z[..., :Fh].clone()
        z2 = _layernorm(z[..., Fh:], axis=-1)
        g = torch.einsum('ts,bsf->btf', w_sp, z2) + b_sp[None, :, None]
        return torch.einsum('bsf,fd->bsd', z1 * g, w_out)
    x = A_x
    xn = _layernorm(x, axis=-1)
    return x + _A_ref(xn, A_wqkv, A_wo) + _B_ref(xn, B_w_in, B_w_sp, B_b_sp, B_w_out)
```

```asm
; @launch kernel=k1_kernel grid=(256,1,1) block=(512,1,1) lds=163840
; @launch kernel=k2_kernel grid=(256,1,1) block=(512,1,1) lds=132096
; @launch kernel=k3_kernel grid=(224,1,1) block=(256,1,1) lds=49152
.amdgcn_target "amdgcn-amd-amdhsa--gfx950"
.text
.globl k1_kernel
.p2align 8
.type k1_kernel,@function
k1_kernel:
  s_cmp_ge_u32 s2, 256
  s_cbranch_scc1 K1_END
  s_load_dwordx4 s[4:7], s[0:1], 0
  s_load_dwordx2 s[8:9], s[0:1], 32
  s_load_dwordx4 s[12:15], s[0:1], 72
  s_getpc_b64 s[44:45]
K1_PC:
  s_and_b32 s46, s2, 1
  s_lshl_b32 s46, s46, 3
  s_bfe_u32 s33, s2, 0x30003
  s_add_u32 s33, s33, s46
  s_lshl_b32 s46, s33, 4
  s_add_u32 s70, s44, s46
  s_addc_u32 s71, s45, 0
  s_add_u32 s70, s70, K1_TAB-K1_PC
  s_addc_u32 s71, s71, 0
  s_load_dwordx4 s[28:31], s[70:71], 0
  v_lshrrev_b32 v1, 6, v0
  s_bfe_u32 s32, s2, 0x20001
  v_readfirstlane_b32 s3, v1
  s_lshl_b32 s32, s32, 2
  s_lshr_b32 s46, s2, 6
  s_add_u32 s32, s32, s46
  v_and_b32 v1, 63, v0
  v_and_b32 v2, 31, v0
  v_bfe_u32 v3, v0, 5, 1
  s_lshr_b32 s34, s3, 2
  s_and_b32 s35, s3, 3
  s_lshl_b32 s36, s32, 2
  s_add_u32 s36, s36, s35
  v_lshrrev_b32 v4, 3, v1
  v_lshrrev_b32 v9, 4, v1
  v_and_b32 v10, 7, v1
  v_xor_b32 v11, v10, v9
  v_lshlrev_b32 v11, 4, v11
  v_mul_u32_u24 v212, 896, v4
  v_add_u32 v212, v212, v11
  v_xor_b32 v11, 64, v11
  v_mul_u32_u24 v213, 896, v4
  v_add_u32 v213, v213, v11
  v_add_u32 v213, 7168-1024, v213
  v_and_b32 v9, 1, v9
  v_lshlrev_b32 v9, 2, v9
  v_xor_b32 v12, v10, v9
  v_lshlrev_b32 v5, 4, v12
  v_mul_u32_u24 v6, 3584, v4
  v_add_u32 v6, v6, v5
  s_cmp_lg_u32 s3, 3
  s_cbranch_scc1 K1_NOCP
  s_sub_u32 s44, s44, K1_PC-k1_kernel
  s_subb_u32 s45, s45, 0
  s_lshr_b32 s46, s2, 3
  s_lshl_b32 s46, s46, 10
  v_lshl_add_u32 v8, v10, 7, s46
  v_min_u32 v8, CODE_END-k1_kernel-4, v8
  global_load_dword v209, v8, s[44:45]
K1_NOCP:
  s_lshl_b32 s46, s32, 7
  s_lshl_b32 s47, s3, 4
  s_add_u32 s46, s46, s47
  s_mul_i32 s60, s46, 896
  s_lshl_b32 s61, s3, 11
  s_lshl_b32 s62, s3, 10
  s_mul_i32 s63, s3, 28672
  s_waitcnt lgkmcnt(0)
  s_mov_b32 s16, s4
  s_and_b32 s17, s5, 0xffff
  s_mov_b32 s18, 1835008
  s_mov_b32 s19, 0x00020000
  s_mov_b32 s20, s8
  s_and_b32 s21, s9, 0xffff
  s_mov_b32 s22, 1605632
  s_mov_b32 s23, 0x00020000
  s_lshr_b32 s46, s28, 16
  s_add_u32 s63, s63, s46
  s_add_u32 m0, s61, 63488
  s_add_u32 s46, s60, 0
  buffer_load_dwordx4 v212, s[16:19], s46 offen lds
  buffer_load_dwordx4 v213, s[16:19], s46 offen offset:1024 lds
  s_add_u32 m0, s62, 6144
  s_add_u32 s46, s63, 0
  buffer_load_dwordx4 v6, s[20:23], s46 offen lds
  s_mov_b32 s24, s14
  s_and_b32 s25, s15, 0xffff
  s_mov_b32 s26, 25165824
  s_mov_b32 s27, 0x00020000
  s_and_b32 s7, s7, 0xffff
  s_and_b32 s9, s9, 0xffff
  s_cmp_eq_u32 s31, -1
  s_cselect_b32 s37, 6, 7
  v_bfe_u32 v10, v2, 1, 3
  v_xor_b32 v10, v10, v3
  v_lshlrev_b32 v10, 4, v10
  v_lshl_add_u32 v10, v2, 7, v10
  s_lshl_b32 s46, s35, 12
  s_add_u32 s46, s46, 63488
  v_add_u32 v8, s46, v10
  v_xor_b32 v9, 32, v8
  v_xor_b32 v10, 64, v8
  v_xor_b32 v11, 0x60, v8
  v_bfe_u32 v12, v1, 2, 2
  v_lshl_add_u32 v13, v3, 3, v12
  v_lshlrev_b32 v13, 7, v13
  v_bfe_u32 v14, v1, 4, 1
  v_lshlrev_b32 v15, 1, v14
  v_bfe_u32 v7, v1, 1, 1
  v_add_u32 v15, v15, v7
  v_lshrrev_b32 v12, 1, v12
  v_lshlrev_b32 v12, 2, v12
  v_xor_b32 v15, v15, v12
  v_lshl_add_u32 v13, v15, 4, v13
  v_and_b32 v15, 1, v1
  v_lshl_add_u32 v7, v15, 3, v13
  v_add_u32 v7, 6144, v7
  s_lshl_b32 s46, s34, 6
  v_xor_b32 v214, s46, v7
  v_lshlrev_b32 v249, 4, v1
  v_lshlrev_b32 v250, 4, v2
  v_mov_b32 v190, 0
  v_mov_b32 v191, 0
  v_mov_b32 v194, 0
  v_mov_b32 v195, 0
  s_mov_b32 s51, 0x3f803f80
  v_and_b32 v12, 15, v1
  v_cmp_eq_u32 vcc, v12, v14
  v_mov_b32 v13, s51
  s_nop 0
  v_cndmask_b32 v236, 0, v13, vcc
  v_mov_b32 v237, v236
  v_mov_b32 v238, v236
  v_mov_b32 v239, v236
  v_and_b32 v12, 3, v0
  v_bfe_u32 v13, v0, 2, 1
  v_lshrrev_b32 v14, 3, v0
  v_lshl_add_u32 v13, v12, 1, v13
  v_lshl_add_u32 v14, v14, 3, v13
  v_mul_u32_u24 v15, 147, v14
  v_lshrrev_b32 v15, 10, v15
  v_mul_u32_u24 v12, 7, v15
  v_sub_u32 v14, v14, v12
  v_lshlrev_b32 v15, 17, v15
  v_lshrrev_b32 v12, 1, v14
  v_lshl_add_u32 v15, v12, 9, v15
  v_and_b32 v14, 1, v14
  v_lshl_add_u32 v15, v14, 3, v15
  v_lshlrev_b32 v12, 2, v0
  v_cmp_gt_u32 vcc, 112, v0
  s_and_saveexec_b64 s[46:47], vcc
  ds_write_b32 v12, v15 offset:5120
  s_mov_b64 exec, -1
  v_mov_b32 v196, 0
  v_mov_b32 v197, 0
  v_mov_b32 v198, 0
  v_mov_b32 v199, 0
  s_lshl_b32 s46, s3, 2
  v_lshl_add_u32 v14, v2, 5, s46
  s_lshl_b32 s46, s35, 7
  v_lshl_add_u32 v15, v2, 2, s46
  s_mul_i32 s67, s3, 3
  s_add_u32 s68, s35, 24
  s_mov_b32 s38, s34
  s_mov_b32 s76, 1
  s_and_b32 s57, s28, 7
  s_bfe_u32 s58, s28, 0x80008
  s_lshl_b32 s58, s58, 1
  s_add_u32 s58, s58, s34
  s_add_u32 m0, s61, 79872
  s_add_u32 s46, s60, 128
  buffer_load_dwordx4 v212, s[16:19], s46 offen lds
  buffer_load_dwordx4 v213, s[16:19], s46 offen offset:1024 lds
  s_add_u32 m0, s62, 14336
  s_add_u32 s46, s63, 229376
  buffer_load_dwordx4 v6, s[20:23], s46 offen lds
  s_add_u32 m0, s61, 112640
  s_add_u32 s46, s60, 256
  buffer_load_dwordx4 v212, s[16:19], s46 offen lds
  buffer_load_dwordx4 v213, s[16:19], s46 offen offset:1024 lds
  s_add_u32 m0, s62, 22528
  s_add_u32 s46, s63, 458752
  buffer_load_dwordx4 v6, s[20:23], s46 offen lds
  s_waitcnt vmcnt(6)
  s_barrier
  s_add_u32 m0, s61, 129024
  s_add_u32 s46, s60, 384
  buffer_load_dwordx4 v212, s[16:19], s46 offen lds
  buffer_load_dwordx4 v213, s[16:19], s46 offen offset:1024 lds
  s_add_u32 m0, s62, 30720
  s_add_u32 s46, s63, 688128
  buffer_load_dwordx4 v6, s[20:23], s46 offen lds
  ds_read_b128 v[16:19], v8 offset:0
  ds_read_b64_tr_b16 v[144:145], v214 offset:0
  ds_read_b64_tr_b16 v[146:147], v214 offset:512
  ds_read_b128 v[20:23], v9 offset:0
  ds_read_b64_tr_b16 v[148:149], v214 offset:2048
  ds_read_b64_tr_b16 v[150:151], v214 offset:2560
  ds_read_b128 v[24:27], v10 offset:0
  ds_read_b64_tr_b16 v[152:153], v214 offset:4096
  ds_read_b64_tr_b16 v[154:155], v214 offset:4608
  ds_read_b128 v[28:31], v11 offset:0
  ds_read_b64_tr_b16 v[156:157], v214 offset:6144
  ds_read_b64_tr_b16 v[158:159], v214 offset:6656
  s_waitcnt lgkmcnt(9)
  v_mfma_f32_32x32x16_bf16 v[128:143], v[144:147], v[16:19], 0
  v_mfma_f32_16x16x32_bf16 v[240:243], v[236:239], v[144:147], 0
  s_waitcnt lgkmcnt(6)
  v_mfma_f32_32x32x16_bf16 v[128:143], v[148:151], v[20:23], v[128:143]
  v_mfma_f32_16x16x32_bf16 v[240:243], v[236:239], v[148:151], v[240:243]
  s_waitcnt lgkmcnt(3)
  v_mfma_f32_32x32x16_bf16 v[128:143], v[152:155], v[24:27], v[128:143]
  v_mfma_f32_16x16x32_bf16 v[240:243], v[236:239], v[152:155], v[240:243]
  s_waitcnt lgkmcnt(0)
  v_mfma_f32_32x32x16_bf16 v[128:143], v[156:159], v[28:31], v[128:143]
  v_mfma_f32_16x16x32_bf16 v[240:243], v[236:239], v[156:159], v[240:243]
  s_cmp_eq_u32 s34, 0
  s_cbranch_scc0 K1_SQ0
  v_dot2c_f32_bf16 v196, s51, v16
  v_dot2c_f32_bf16 v197, s51, v17
  v_dot2c_f32_bf16 v198, s51, v18
  v_dot2c_f32_bf16 v199, s51, v19
  v_dot2c_f32_bf16 v196, s51, v20
  v_dot2c_f32_bf16 v197, s51, v21
  v_dot2c_f32_bf16 v198, s51, v22
  v_dot2c_f32_bf16 v199, s51, v23
  v_dot2c_f32_bf16 v196, s51, v24
  v_dot2c_f32_bf16 v197, s51, v25
  v_dot2c_f32_bf16 v198, s51, v26
  v_dot2c_f32_bf16 v199, s51, v27
  v_dot2c_f32_bf16 v196, s51, v28
  v_dot2c_f32_bf16 v197, s51, v29
  v_dot2c_f32_bf16 v198, s51, v30
  v_dot2c_f32_bf16 v199, s51, v31
  s_branch K1_SD0
K1_SQ0:
  v_dot2c_f32_bf16 v196, v16, v16
  v_dot2c_f32_bf16 v197, v17, v17
  v_dot2c_f32_bf16 v198, v18, v18
  v_dot2c_f32_bf16 v199, v19, v19
  v_dot2c_f32_bf16 v196, v20, v20
  v_dot2c_f32_bf16 v197, v21, v21
  v_dot2c_f32_bf16 v198, v22, v22
  v_dot2c_f32_bf16 v199, v23, v23
  v_dot2c_f32_bf16 v196, v24, v24
  v_dot2c_f32_bf16 v197, v25, v25
  v_dot2c_f32_bf16 v198, v26, v26
  v_dot2c_f32_bf16 v199, v27, v27
  v_dot2c_f32_bf16 v196, v28, v28
  v_dot2c_f32_bf16 v197, v29, v29
  v_dot2c_f32_bf16 v198, v30, v30
  v_dot2c_f32_bf16 v199, v31, v31
K1_SD0:
  s_waitcnt vmcnt(6)
  s_barrier
  s_add_u32 m0, s61, 145408
  s_add_u32 s46, s60, 512
  buffer_load_dwordx4 v212, s[16:19], s46 offen lds
  buffer_load_dwordx4 v213, s[16:19], s46 offen offset:1024 lds
  s_add_u32 m0, s62, 38912
  s_add_u32 s46, s63, 917504
  buffer_load_dwordx4 v6, s[20:23], s46 offen lds
  ds_read_b128 v[32:35], v8 offset:16384
  ds_read_b64_tr_b16 v[144:145], v214 offset:8192
  ds_read_b64_tr_b16 v[146:147], v214 offset:8704
  ds_read_b128 v[36:39], v9 offset:16384
  ds_read_b64_tr_b16 v[148:149], v214 offset:10240
  ds_read_b64_tr_b16 v[150:151], v214 offset:10752
  ds_read_b128 v[40:43], v10 offset:16384
  ds_read_b64_tr_b16 v[152:153], v214 offset:12288
  ds_read_b64_tr_b16 v[154:155], v214 offset:12800
  ds_read_b128 v[44:47], v11 offset:16384
  ds_read_b64_tr_b16 v[156:157], v214 offset:14336
  ds_read_b64_tr_b16 v[158:159], v214 offset:14848
  s_waitcnt lgkmcnt(9)
  v_mfma_f32_32x32x16_bf16 v[128:143], v[144:147], v[32:35], v[128:143]
  v_mfma_f32_16x16x32_bf16 v[240:243], v[236:239], v[144:147], v[240:243]
  s_waitcnt lgkmcnt(6)
  v_mfma_f32_32x32x16_bf16 v[128:143], v[148:151], v[36:39], v[128:143]
  v_mfma_f32_16x16x32_bf16 v[240:243], v[236:239], v[148:151], v[240:243]
  s_waitcnt lgkmcnt(3)
  v_mfma_f32_32x32x16_bf16 v[128:143], v[152:155], v[40:43], v[128:143]
  v_mfma_f32_16x16x32_bf16 v[240:243], v[236:239], v[152:155], v[240:243]
  s_waitcnt lgkmcnt(0)
  v_mfma_f32_32x32x16_bf16 v[128:143], v[156:159], v[44:47], v[128:143]
  v_mfma_f32_16x16x32_bf16 v[240:243], v[236:239], v[156:159], v[240:243]
  s_cmp_eq_u32 s34, 0
  s_cbranch_scc0 K1_SQ1
  v_dot2c_f32_bf16 v196, s51, v32
  v_dot2c_f32_bf16 v197, s51, v33
  v_dot2c_f32_bf16 v198, s51, v34
  v_dot2c_f32_bf16 v199, s51, v35
  v_dot2c_f32_bf16 v196, s51, v36
  v_dot2c_f32_bf16 v197, s51, v37
  v_dot2c_f32_bf16 v198, s51, v38
  v_dot2c_f32_bf16 v199, s51, v39
  v_dot2c_f32_bf16 v196, s51, v40
  v_dot2c_f32_bf16 v197, s51, v41
  v_dot2c_f32_bf16 v198, s51, v42
  v_dot2c_f32_bf16 v199, s51, v43
  v_dot2c_f32_bf16 v196, s51, v44
  v_dot2c_f32_bf16 v197, s51, v45
  v_dot2c_f32_bf16 v198, s51, v46
  v_dot2c_f32_bf16 v199, s51, v47
  s_branch K1_SD1
K1_SQ1:
  v_dot2c_f32_bf16 v196, v32, v32
  v_dot2c_f32_bf16 v197, v33, v33
  v_dot2c_f32_bf16 v198, v34, v34
  v_dot2c_f32_bf16 v199, v35, v35
  v_dot2c_f32_bf16 v196, v36, v36
  v_dot2c_f32_bf16 v197, v37, v37
  v_dot2c_f32_bf16 v198, v38, v38
  v_dot2c_f32_bf16 v199, v39, v39
  v_dot2c_f32_bf16 v196, v40, v40
  v_dot2c_f32_bf16 v197, v41, v41
  v_dot2c_f32_bf16 v198, v42, v42
  v_dot2c_f32_bf16 v199, v43, v43
  v_dot2c_f32_bf16 v196, v44, v44
  v_dot2c_f32_bf16 v197, v45, v45
  v_dot2c_f32_bf16 v198, v46, v46
  v_dot2c_f32_bf16 v199, v47, v47
K1_SD1:
  s_waitcnt vmcnt(6)
  s_barrier
  s_add_u32 m0, s61, 6144
  s_add_u32 s46, s60, 640
  buffer_load_dwordx4 v212, s[16:19], s46 offen lds
  buffer_load_dwordx4 v213, s[16:19], s46 offen offset:1024 lds
  s_add_u32 m0, s62, 47104
  s_add_u32 s46, s63, 1146880
  buffer_load_dwordx4 v6, s[20:23], s46 offen lds
  ds_read_b128 v[48:51], v8 offset:49152
  ds_read_b64_tr_b16 v[144:145], v214 offset:16384
  ds_read_b64_tr_b16 v[146:147], v214 offset:16896
  ds_read_b128 v[52:55], v9 offset:49152
  ds_read_b64_tr_b16 v[148:149], v214 offset:18432
  ds_read_b64_tr_b16 v[150:151], v214 offset:18944
  ds_read_b128 v[56:59], v10 offset:49152
  ds_read_b64_tr_b16 v[152:153], v214 offset:20480
  ds_read_b64_tr_b16 v[154:155], v214 offset:20992
  ds_read_b128 v[60:63], v11 offset:49152
  ds_read_b64_tr_b16 v[156:157], v214 offset:22528
  ds_read_b64_tr_b16 v[158:159], v214 offset:23040
  s_waitcnt lgkmcnt(9)
  v_mfma_f32_32x32x16_bf16 v[128:143], v[144:147], v[48:51], v[128:143]
  v_mfma_f32_16x16x32_bf16 v[240:243], v[236:239], v[144:147], v[240:243]
  s_waitcnt lgkmcnt(6)
  v_mfma_f32_32x32x16_bf16 v[128:143], v[148:151], v[52:55], v[128:143]
  v_mfma_f32_16x16x32_bf16 v[240:243], v[236:239], v[148:151], v[240:243]
  s_waitcnt lgkmcnt(3)
  v_mfma_f32_32x32x16_bf16 v[128:143], v[152:155], v[56:59], v[128:143]
  v_mfma_f32_16x16x32_bf16 v[240:243], v[236:239], v[152:155], v[240:243]
  s_waitcnt lgkmcnt(0)
  v_mfma_f32_32x32x16_bf16 v[128:143], v[156:159], v[60:63], v[128:143]
  v_mfma_f32_16x16x32_bf16 v[240:243], v[236:239], v[156:159], v[240:243]
  s_cmp_eq_u32 s34, 0
  s_cbranch_scc0 K1_SQ2
  v_dot2c_f32_bf16 v196, s51, v48
  v_dot2c_f32_bf16 v197, s51, v49
  v_dot2c_f32_bf16 v198, s51, v50
  v_dot2c_f32_bf16 v199, s51, v51
  v_dot2c_f32_bf16 v196, s51, v52
  v_dot2c_f32_bf16 v197, s51, v53
  v_dot2c_f32_bf16 v198, s51, v54
  v_dot2c_f32_bf16 v199, s51, v55
  v_dot2c_f32_bf16 v196, s51, v56
  v_dot2c_f32_bf16 v197, s51, v57
  v_dot2c_f32_bf16 v198, s51, v58
  v_dot2c_f32_bf16 v199, s51, v59
  v_dot2c_f32_bf16 v196, s51, v60
  v_dot2c_f32_bf16 v197, s51, v61
  v_dot2c_f32_bf16 v198, s51, v62
  v_dot2c_f32_bf16 v199, s51, v63
  s_branch K1_SD2
K1_SQ2:
  v_dot2c_f32_bf16 v196, v48, v48
  v_dot2c_f32_bf16 v197, v49, v49
  v_dot2c_f32_bf16 v198, v50, v50
  v_dot2c_f32_bf16 v199, v51, v51
  v_dot2c_f32_bf16 v196, v52, v52
  v_dot2c_f32_bf16 v197, v53, v53
  v_dot2c_f32_bf16 v198, v54, v54
  v_dot2c_f32_bf16 v199, v55, v55
  v_dot2c_f32_bf16 v196, v56, v56
  v_dot2c_f32_bf16 v197, v57, v57
  v_dot2c_f32_bf16 v198, v58, v58
  v_dot2c_f32_bf16 v199, v59, v59
  v_dot2c_f32_bf16 v196, v60, v60
  v_dot2c_f32_bf16 v197, v61, v61
  v_dot2c_f32_bf16 v198, v62, v62
  v_dot2c_f32_bf16 v199, v63, v63
K1_SD2:
  s_waitcnt vmcnt(6)
  s_barrier
  s_add_u32 m0, s61, 112640
  s_add_u32 s46, s60, 768
  buffer_load_dwordx4 v212, s[16:19], s46 offen lds
  buffer_load_dwordx4 v213, s[16:19], s46 offen offset:1024 lds
  s_add_u32 m0, s62, 55296
  s_add_u32 s46, s63, 1376256
  buffer_load_dwordx4 v6, s[20:23], s46 offen lds
  v_add_u32 v12, 65536, v8
  ds_read_b128 v[64:67], v12
  ds_read_b64_tr_b16 v[144:145], v214 offset:24576
  ds_read_b64_tr_b16 v[146:147], v214 offset:25088
  v_add_u32 v12, 65536, v9
  ds_read_b128 v[68:71], v12
  ds_read_b64_tr_b16 v[148:149], v214 offset:26624
  ds_read_b64_tr_b16 v[150:151], v214 offset:27136
  v_add_u32 v12, 65536, v10
  ds_read_b128 v[72:75], v12
  ds_read_b64_tr_b16 v[152:153], v214 offset:28672
  ds_read_b64_tr_b16 v[154:155], v214 offset:29184
  v_add_u32 v12, 65536, v11
  ds_read_b128 v[76:79], v12
  ds_read_b64_tr_b16 v[156:157], v214 offset:30720
  ds_read_b64_tr_b16 v[158:159], v214 offset:31232
  s_waitcnt lgkmcnt(9)
  v_mfma_f32_32x32x16_bf16 v[128:143], v[144:147], v[64:67], v[128:143]
  v_mfma_f32_16x16x32_bf16 v[240:243], v[236:239], v[144:147], v[240:243]
  s_waitcnt lgkmcnt(6)
  v_mfma_f32_32x32x16_bf16 v[128:143], v[148:151], v[68:71], v[128:143]
  v_mfma_f32_16x16x32_bf16 v[240:243], v[236:239], v[148:151], v[240:243]
  s_waitcnt lgkmcnt(3)
  v_mfma_f32_32x32x16_bf16 v[128:143], v[152:155], v[72:75], v[128:143]
  v_mfma_f32_16x16x32_bf16 v[240:243], v[236:239], v[152:155], v[240:243]
  s_waitcnt lgkmcnt(0)
  v_mfma_f32_32x32x16_bf16 v[128:143], v[156:159], v[76:79], v[128:143]
  v_mfma_f32_16x16x32_bf16 v[240:243], v[236:239], v[156:159], v[240:243]
  s_cmp_eq_u32 s34, 0
  s_cbranch_scc0 K1_SQ3
  v_dot2c_f32_bf16 v196, s51, v64
  v_dot2c_f32_bf16 v197, s51, v65
  v_dot2c_f32_bf16 v198, s51, v66
  v_dot2c_f32_bf16 v199, s51, v67
  v_dot2c_f32_bf16 v196, s51, v68
  v_dot2c_f32_bf16 v197, s51, v69
  v_dot2c_f32_bf16 v198, s51, v70
  v_dot2c_f32_bf16 v199, s51, v71
  v_dot2c_f32_bf16 v196, s51, v72
  v_dot2c_f32_bf16 v197, s51, v73
  v_dot2c_f32_bf16 v198, s51, v74
  v_dot2c_f32_bf16 v199, s51, v75
  v_dot2c_f32_bf16 v196, s51, v76
  v_dot2c_f32_bf16 v197, s51, v77
  v_dot2c_f32_bf16 v198, s51, v78
  v_dot2c_f32_bf16 v199, s51, v79
  s_branch K1_SD3
K1_SQ3:
  v_dot2c_f32_bf16 v196, v64, v64
  v_dot2c_f32_bf16 v197, v65, v65
  v_dot2c_f32_bf16 v198, v66, v66
  v_dot2c_f32_bf16 v199, v67, v67
  v_dot2c_f32_bf16 v196, v68, v68
  v_dot2c_f32_bf16 v197, v69, v69
  v_dot2c_f32_bf16 v198, v70, v70
  v_dot2c_f32_bf16 v199, v71, v71
  v_dot2c_f32_bf16 v196, v72, v72
  v_dot2c_f32_bf16 v197, v73, v73
  v_dot2c_f32_bf16 v198, v74, v74
  v_dot2c_f32_bf16 v199, v75, v75
  v_dot2c_f32_bf16 v196, v76, v76
  v_dot2c_f32_bf16 v197, v77, v77
  v_dot2c_f32_bf16 v198, v78, v78
  v_dot2c_f32_bf16 v199, v79, v79
K1_SD3:
  s_waitcnt vmcnt(6)
  s_barrier
  s_mov_b32 s64, s29
  s_call_b64 s[42:43], K1_DSET
  s_lshl_b32 s46, s67, 11
  s_add_u32 s69, s46, 63488
  s_mov_b32 m0, s69
  s_add_u32 s69, s69, 1024
  buffer_load_dwordx4 v6, s[20:23], s40 offen lds
  s_add_u32 s40, s40, s41
  s_mov_b32 m0, s69
  s_add_u32 s69, s69, 1024
  buffer_load_dwordx4 v6, s[20:23], s40 offen lds
  s_add_u32 s40, s40, s41
  v_add_u32 v12, 81920, v8
  ds_read_b128 v[80:83], v12
  ds_read_b64_tr_b16 v[144:145], v214 offset:32768
  ds_read_b64_tr_b16 v[146:147], v214 offset:33280
  v_add_u32 v12, 81920, v9
  ds_read_b128 v[84:87], v12
  ds_read_b64_tr_b16 v[148:149], v214 offset:34816
  ds_read_b64_tr_b16 v[150:151], v214 offset:35328
  v_add_u32 v12, 81920, v10
  ds_read_b128 v[88:91], v12
  ds_read_b64_tr_b16 v[152:153], v214 offset:36864
  ds_read_b64_tr_b16 v[154:155], v214 offset:37376
  v_add_u32 v12, 81920, v11
  ds_read_b128 v[92:95], v12
  ds_read_b64_tr_b16 v[156:157], v214 offset:38912
  ds_read_b64_tr_b16 v[158:159], v214 offset:39424
  s_waitcnt lgkmcnt(9)
  v_mfma_f32_32x32x16_bf16 v[128:143], v[144:147], v[80:83], v[128:143]
  v_mfma_f32_16x16x32_bf16 v[240:243], v[236:239], v[144:147], v[240:243]
  s_waitcnt lgkmcnt(6)
  v_mfma_f32_32x32x16_bf16 v[128:143], v[148:151], v[84:87], v[128:143]
  v_mfma_f32_16x16x32_bf16 v[240:243], v[236:239], v[148:151], v[240:243]
  s_waitcnt lgkmcnt(3)
  v_mfma_f32_32x32x16_bf16 v[128:143], v[152:155], v[88:91], v[128:143]
  v_mfma_f32_16x16x32_bf16 v[240:243], v[236:239], v[152:155], v[240:243]
  s_waitcnt lgkmcnt(0)
  v_mfma_f32_32x32x16_bf16 v[128:143], v[156:159], v[92:95], v[128:143]
  v_mfma_f32_16x16x32_bf16 v[240:243], v[236:239], v[156:159], v[240:243]
  s_cmp_eq_u32 s34, 0
  s_cbranch_scc0 K1_SQ4
  v_dot2c_f32_bf16 v196, s51, v80
  v_dot2c_f32_bf16 v197, s51, v81
  v_dot2c_f32_bf16 v198, s51, v82
  v_dot2c_f32_bf16 v199, s51, v83
  v_dot2c_f32_bf16 v196, s51, v84
  v_dot2c_f32_bf16 v197, s51, v85
  v_dot2c_f32_bf16 v198, s51, v86
  v_dot2c_f32_bf16 v199, s51, v87
  v_dot2c_f32_bf16 v196, s51, v88
  v_dot2c_f32_bf16 v197, s51, v89
  v_dot2c_f32_bf16 v198, s51, v90
  v_dot2c_f32_bf16 v199, s51, v91
  v_dot2c_f32_bf16 v196, s51, v92
  v_dot2c_f32_bf16 v197, s51, v93
  v_dot2c_f32_bf16 v198, s51, v94
  v_dot2c_f32_bf16 v199, s51, v95
  s_branch K1_SD4
K1_SQ4:
  v_dot2c_f32_bf16 v196, v80, v80
  v_dot2c_f32_bf16 v197, v81, v81
  v_dot2c_f32_bf16 v198, v82, v82
  v_dot2c_f32_bf16 v199, v83, v83
  v_dot2c_f32_bf16 v196, v84, v84
  v_dot2c_f32_bf16 v197, v85, v85
  v_dot2c_f32_bf16 v198, v86, v86
  v_dot2c_f32_bf16 v199, v87, v87
  v_dot2c_f32_bf16 v196, v88, v88
  v_dot2c_f32_bf16 v197, v89, v89
  v_dot2c_f32_bf16 v198, v90, v90
  v_dot2c_f32_bf16 v199, v91, v91
  v_dot2c_f32_bf16 v196, v92, v92
  v_dot2c_f32_bf16 v197, v93, v93
  v_dot2c_f32_bf16 v198, v94, v94
  v_dot2c_f32_bf16 v199, v95, v95
K1_SD4:
  s_waitcnt vmcnt(5)
  s_barrier
  s_mov_b32 m0, s69
  s_add_u32 s69, s69, 1024
  buffer_load_dwordx4 v6, s[20:23], s40 offen lds
  s_add_u32 s40, s40, s41
  s_mov_b32 m0, s69
  s_add_u32 s69, s69, 1024
  buffer_load_dwordx4 v6, s[20:23], s40 offen lds
  s_add_u32 s40, s40, s41
  v_add_u32 v12, 4294909952, v8
  ds_read_b128 v[96:99], v12
  ds_read_b64_tr_b16 v[144:145], v214 offset:40960
  ds_read_b64_tr_b16 v[146:147], v214 offset:41472
  v_add_u32 v12, 4294909952, v9
  ds_read_b128 v[100:103], v12
  ds_read_b64_tr_b16 v[148:149], v214 offset:43008
  ds_read_b64_tr_b16 v[150:151], v214 offset:43520
  v_add_u32 v12, 4294909952, v10
  ds_read_b128 v[104:107], v12
  ds_read_b64_tr_b16 v[152:153], v214 offset:45056
  ds_read_b64_tr_b16 v[154:155], v214 offset:45568
  v_add_u32 v12, 4294909952, v11
  ds_read_b128 v[108:111], v12
  ds_read_b64_tr_b16 v[156:157], v214 offset:47104
  ds_read_b64_tr_b16 v[158:159], v214 offset:47616
  s_waitcnt lgkmcnt(9)
  v_mfma_f32_32x32x16_bf16 v[128:143], v[144:147], v[96:99], v[128:143]
  v_mfma_f32_16x16x32_bf16 v[240:243], v[236:239], v[144:147], v[240:243]
  s_waitcnt lgkmcnt(6)
  v_mfma_f32_32x32x16_bf16 v[128:143], v[148:151], v[100:103], v[128:143]
  v_mfma_f32_16x16x32_bf16 v[240:243], v[236:239], v[148:151], v[240:243]
  s_waitcnt lgkmcnt(3)
  v_mfma_f32_32x32x16_bf16 v[128:143], v[152:155], v[104:107], v[128:143]
  v_mfma_f32_16x16x32_bf16 v[240:243], v[236:239], v[152:155], v[240:243]
  s_waitcnt lgkmcnt(0)
  v_mfma_f32_32x32x16_bf16 v[128:143], v[156:159], v[108:111], v[128:143]
  v_mfma_f32_16x16x32_bf16 v[240:243], v[236:239], v[156:159], v[240:243]
  s_cmp_eq_u32 s34, 0
  s_cbranch_scc0 K1_SQ5
  v_dot2c_f32_bf16 v196, s51, v96
  v_dot2c_f32_bf16 v197, s51, v97
  v_dot2c_f32_bf16 v198, s51, v98
  v_dot2c_f32_bf16 v199, s51, v99
  v_dot2c_f32_bf16 v196, s51, v100
  v_dot2c_f32_bf16 v197, s51, v101
  v_dot2c_f32_bf16 v198, s51, v102
  v_dot2c_f32_bf16 v199, s51, v103
  v_dot2c_f32_bf16 v196, s51, v104
  v_dot2c_f32_bf16 v197, s51, v105
  v_dot2c_f32_bf16 v198, s51, v106
  v_dot2c_f32_bf16 v199, s51, v107
  v_dot2c_f32_bf16 v196, s51, v108
  v_dot2c_f32_bf16 v197, s51, v109
  v_dot2c_f32_bf16 v198, s51, v110
  v_dot2c_f32_bf16 v199, s51, v111
  s_branch K1_SD5
K1_SQ5:
  v_dot2c_f32_bf16 v196, v96, v96
  v_dot2c_f32_bf16 v197, v97, v97
  v_dot2c_f32_bf16 v198, v98, v98
  v_dot2c_f32_bf16 v199, v99, v99
  v_dot2c_f32_bf16 v196, v100, v100
  v_dot2c_f32_bf16 v197, v101, v101
  v_dot2c_f32_bf16 v198, v102, v102
  v_dot2c_f32_bf16 v199, v103, v103
  v_dot2c_f32_bf16 v196, v104, v104
  v_dot2c_f32_bf16 v197, v105, v105
  v_dot2c_f32_bf16 v198, v106, v106
  v_dot2c_f32_bf16 v199, v107, v107
  v_dot2c_f32_bf16 v196, v108, v108
  v_dot2c_f32_bf16 v197, v109, v109
  v_dot2c_f32_bf16 v198, v110, v110
  v_dot2c_f32_bf16 v199, v111, v111
K1_SD5:
  s_waitcnt vmcnt(4)
  s_barrier
  s_mov_b32 m0, s69
  s_add_u32 s69, s69, 1024
  buffer_load_dwordx4 v6, s[20:23], s40 offen lds
  s_add_u32 s40, s40, s41
  s_mov_b32 m0, s69
  s_add_u32 s69, s69, 1024
  buffer_load_dwordx4 v6, s[20:23], s40 offen lds
  s_add_u32 s40, s40, s41
  ds_read_b128 v[112:115], v8 offset:49152
  ds_read_b64_tr_b16 v[144:145], v214 offset:49152
  ds_read_b64_tr_b16 v[146:147], v214 offset:49664
  ds_read_b128 v[116:119], v9 offset:49152
  ds_read_b64_tr_b16 v[148:149], v214 offset:51200
  ds_read_b64_tr_b16 v[150:151], v214 offset:51712
  ds_read_b128 v[120:123], v10 offset:49152
  ds_read_b64_tr_b16 v[152:153], v214 offset:53248
  ds_read_b64_tr_b16 v[154:155], v214 offset:53760
  ds_read_b128 v[124:127], v11 offset:49152
  ds_read_b64_tr_b16 v[156:157], v214 offset:55296
  ds_read_b64_tr_b16 v[158:159], v214 offset:55808
  s_waitcnt lgkmcnt(9)
  v_mfma_f32_32x32x16_bf16 v[128:143], v[144:147], v[112:115], v[128:143]
  v_mfma_f32_16x16x32_bf16 v[240:243], v[236:239], v[144:147], v[240:243]
  s_waitcnt lgkmcnt(6)
  v_mfma_f32_32x32x16_bf16 v[128:143], v[148:151], v[116:119], v[128:143]
  v_mfma_f32_16x16x32_bf16 v[240:243], v[236:239], v[148:151], v[240:243]
  s_waitcnt lgkmcnt(3)
  v_mfma_f32_32x32x16_bf16 v[128:143], v[152:155], v[120:123], v[128:143]
  v_mfma_f32_16x16x32_bf16 v[240:243], v[236:239], v[152:155], v[240:243]
  s_waitcnt lgkmcnt(0)
  v_mfma_f32_32x32x16_bf16 v[128:143], v[156:159], v[124:127], v[128:143]
  v_mfma_f32_16x16x32_bf16 v[240:243], v[236:239], v[156:159], v[240:243]
  s_cmp_eq_u32 s34, 0
  s_cbranch_scc0 K1_SQ6
  v_dot2c_f32_bf16 v196, s51, v112
  v_dot2c_f32_bf16 v197, s51, v113
  v_dot2c_f32_bf16 v198, s51, v114
  v_dot2c_f32_bf16 v199, s51, v115
  v_dot2c_f32_bf16 v196, s51, v116
  v_dot2c_f32_bf16 v197, s51, v117
  v_dot2c_f32_bf16 v198, s51, v118
  v_dot2c_f32_bf16 v199, s51, v119
  v_dot2c_f32_bf16 v196, s51, v120
  v_dot2c_f32_bf16 v197, s51, v121
  v_dot2c_f32_bf16 v198, s51, v122
  v_dot2c_f32_bf16 v199, s51, v123
  v_dot2c_f32_bf16 v196, s51, v124
  v_dot2c_f32_bf16 v197, s51, v125
  v_dot2c_f32_bf16 v198, s51, v126
  v_dot2c_f32_bf16 v199, s51, v127
  s_branch K1_SD6
K1_SQ6:
  v_dot2c_f32_bf16 v196, v112, v112
  v_dot2c_f32_bf16 v197, v113, v113
  v_dot2c_f32_bf16 v198, v114, v114
  v_dot2c_f32_bf16 v199, v115, v115
  v_dot2c_f32_bf16 v196, v116, v116
  v_dot2c_f32_bf16 v197, v117, v117
  v_dot2c_f32_bf16 v198, v118, v118
  v_dot2c_f32_bf16 v199, v119, v119
  v_dot2c_f32_bf16 v196, v120, v120
  v_dot2c_f32_bf16 v197, v121, v121
  v_dot2c_f32_bf16 v198, v122, v122
  v_dot2c_f32_bf16 v199, v123, v123
  v_dot2c_f32_bf16 v196, v124, v124
  v_dot2c_f32_bf16 v197, v125, v125
  v_dot2c_f32_bf16 v198, v126, v126
  v_dot2c_f32_bf16 v199, v127, v127
K1_SD6:
  s_nop 1
  v_add_f32 v196, v196, v197
  v_add_f32 v198, v198, v199
  v_add_f32 v196, v196, v198
  s_lshl_b32 s46, s3, 8
  s_add_u32 s46, s46, 129024
  v_lshl_add_u32 v12, v1, 2, s46
  ds_write_b32 v12, v196
  v_mul_f32 v240, 0.5, v240
  v_mul_f32 v241, 0.5, v241
  v_mul_f32 v240, 0.5, v240
  v_mul_f32 v241, 0.5, v241
  v_mov_b32 v242, 0
  s_lshl_b32 s46, s34, 10
  v_add_u32 v13, s46, v14
  v_xor_b32 v12, 16, v13
  s_mov_b64 exec, 0xffff
  ds_write_b32 v13, v240 offset:0
  ds_write_b32 v13, v241 offset:512
  ds_write_b32 v12, v242 offset:0
  ds_write_b32 v12, v242 offset:512
  s_mov_b64 exec, -1
  s_lshl_b32 s46, s35, 8
  s_add_u32 s46, s46, 129024
  v_lshl_add_u32 v12, v2, 2, s46
  s_lshl_b32 s46, s34, 10
  v_lshl_add_u32 v13, v2, 5, s46
  s_waitcnt lgkmcnt(0)
  s_barrier
  ds_read_b32 v196, v12
  ds_read_b32 v197, v12 offset:128
  ds_read_b32 v198, v12 offset:1024
  ds_read_b32 v199, v12 offset:1152
  ds_read_b128 v[200:203], v13 offset:0
  ds_read_b128 v[204:207], v13 offset:16
  s_mov_b32 s39, 63488
  s_call_b64 s[42:43], K1_DMX
  s_waitcnt lgkmcnt(2)
  v_add_f32 v196, v196, v197
  v_add_f32 v197, v198, v199
  v_mul_f32 v196, 0x3b124925, v196
  v_mul_f32 v197, 0x3b124925, v197
  v_fma_f32 v197, -v196, v196, v197
  v_max_f32 v197, 0, v197
  v_add_f32 v197, 0x3727c5ac, v197
  v_rsq_f32 v248, v197
  v_cvt_f32_u32 v198, v3
  v_subrev_f32 v198, 1.0, v198
  v_mul_f32 v196, v196, v198
  ds_write_b32 v15, v248 offset:4608
  v_mul_f32 v251, 0xc0135761, v248
  v_cvt_pk_bf16_f32 v188, v196, v196
  v_mul_f32 v252, v248, v248
  v_lshlrev_b32 v197, 16, v188
  v_rcp_f32 v253, v248
  v_sub_f32 v197, v196, v197
  v_mul_f32 v252, v252, v248
  v_cvt_pk_bf16_f32 v189, v197, 0
  v_mul_f32 v252, 0xbdd2d3e8, v252
  s_waitcnt lgkmcnt(1)
  v_add_f32 v200, v200, v201
  v_add_f32 v202, v202, v203
  v_add_f32 v204, v204, v205
  v_add_f32 v206, v206, v207
  v_add_f32 v200, v200, v202
  v_add_f32 v204, v204, v206
  v_add_f32 v200, v200, v204
  v_cvt_pk_bf16_f32 v193, v200, v200
  v_lshlrev_b32 v201, 16, v193
  v_sub_f32 v201, v200, v201
  v_cvt_pk_bf16_f32 v192, v200, v201
  s_lshl_b32 s46, s33, 6
  s_add_u32 s46, s46, s36
  v_mfma_f32_32x32x16_bf16 v[128:143], v[192:195], v[188:191], v[128:143]
  s_lshl_b32 s46, s46, 11
  s_add_u32 s46, s46, 2098696
  s_cmp_eq_u32 s34, 1
  s_cselect_b32 s46, s46, 0x7ff00000
  v_mov_b32 v12, 0x3f803f80
  v_mov_b32 v13, 0x3f80
  buffer_store_dwordx2 v[12:13], v250, s[24:27], s46 offen sc1
  s_branch K1_EZ
K1_M:
  s_bfe_u32 s47, s28, 0x10004
  s_or_b32 s53, s34, s47
  s_lshl_b32 s46, s53, 6
  v_xor_b32 v8, s46, v7
  s_bfe_u32 s46, s38, 0x10001
  s_mul_i32 s47, s46, 57344
  v_add_u32 v8, s47, v8
  ds_read_b64_tr_b16 v[144:145], v8 offset:0
  ds_read_b64_tr_b16 v[146:147], v8 offset:512
  ds_read_b64_tr_b16 v[148:149], v8 offset:2048
  ds_read_b64_tr_b16 v[150:151], v8 offset:2560
  ds_read_b64_tr_b16 v[152:153], v8 offset:4096
  ds_read_b64_tr_b16 v[154:155], v8 offset:4608
  ds_read_b64_tr_b16 v[156:157], v8 offset:6144
  ds_read_b64_tr_b16 v[158:159], v8 offset:6656
  ds_read_b64_tr_b16 v[160:161], v8 offset:8192
  ds_read_b64_tr_b16 v[162:163], v8 offset:8704
  ds_read_b64_tr_b16 v[164:165], v8 offset:10240
  ds_read_b64_tr_b16 v[166:167], v8 offset:10752
  s_lshl_b32 s46, s46, 11
  s_lshl_b32 s47, s53, 10
  s_add_u32 s46, s46, s47
  v_lshl_add_u32 v9, v2, 5, s46
  s_and_b32 s57, s28, 7
  s_bfe_u32 s58, s28, 0x80008
  s_lshl_b32 s58, s58, 1
  s_add_u32 s58, s58, s53
  s_lshl_b32 s46, s58, 5
  v_lshl_add_u32 v10, v3, 4, s46
  s_cmp_eq_u32 s57, 4
  s_cbranch_scc1 K1_MF_D
  s_waitcnt lgkmcnt(8)
  v_mfma_f32_32x32x16_bf16 v[128:143], v[144:147], v[16:19], 0
  ds_read_b64_tr_b16 v[168:169], v8 offset:12288
  ds_read_b64_tr_b16 v[170:171], v8 offset:12800
  v_mfma_f32_32x32x16_bf16 v[128:143], v[148:151], v[20:23], v[128:143]
  ds_read_b64_tr_b16 v[144:145], v8 offset:14336
  ds_read_b64_tr_b16 v[146:147], v8 offset:14848
  s_waitcnt lgkmcnt(8)
  v_mfma_f32_32x32x16_bf16 v[128:143], v[152:155], v[24:27], v[128:143]
  ds_read_b64_tr_b16 v[148:149], v8 offset:16384
  ds_read_b64_tr_b16 v[150:151], v8 offset:16896
  v_mfma_f32_32x32x16_bf16 v[128:143], v[156:159], v[28:31], v[128:143]
  ds_read_b64_tr_b16 v[152:153], v8 offset:18432
  ds_read_b64_tr_b16 v[154:155], v8 offset:18944
  s_waitcnt lgkmcnt(8)
  v_mfma_f32_32x32x16_bf16 v[128:143], v[160:163], v[32:35], v[128:143]
  ds_read_b64_tr_b16 v[156:157], v8 offset:20480
  ds_read_b64_tr_b16 v[158:159], v8 offset:20992
  v_mfma_f32_32x32x16_bf16 v[128:143], v[164:167], v[36:39], v[128:143]
  ds_read_b64_tr_b16 v[160:161], v8 offset:22528
  ds_read_b64_tr_b16 v[162:163], v8 offset:23040
  s_waitcnt lgkmcnt(8)
  v_mfma_f32_32x32x16_bf16 v[128:143], v[168:171], v[40:43], v[128:143]
  ds_read_b64_tr_b16 v[164:165], v8 offset:24576
  ds_read_b64_tr_b16 v[166:167], v8 offset:25088
  v_mfma_f32_32x32x16_bf16 v[128:143], v[144:147], v[44:47], v[128:143]
  ds_read_b64_tr_b16 v[168:169], v8 offset:26624
  ds_read_b64_tr_b16 v[170:171], v8 offset:27136
  s_waitcnt lgkmcnt(8)
  v_mfma_f32_32x32x16_bf16 v[128:143], v[148:151], v[48:51], v[128:143]
  ds_read_b64_tr_b16 v[144:145], v8 offset:28672
  ds_read_b64_tr_b16 v[146:147], v8 offset:29184
  v_mfma_f32_32x32x16_bf16 v[128:143], v[152:155], v[52:55], v[128:143]
  ds_read_b64_tr_b16 v[148:149], v8 offset:30720
  ds_read_b64_tr_b16 v[150:151], v8 offset:31232
  s_waitcnt lgkmcnt(8)
  v_mfma_f32_32x32x16_bf16 v[128:143], v[156:159], v[56:59], v[128:143]
  ds_read_b64_tr_b16 v[152:153], v8 offset:32768
  ds_read_b64_tr_b16 v[154:155], v8 offset:33280
  v_mfma_f32_32x32x16_bf16 v[128:143], v[160:163], v[60:63], v[128:143]
  ds_read_b64_tr_b16 v[156:157], v8 offset:34816
  ds_read_b64_tr_b16 v[158:159], v8 offset:35328
  s_waitcnt lgkmcnt(8)
  v_mfma_f32_32x32x16_bf16 v[128:143], v[164:167], v[64:67], v[128:143]
  ds_read_b64_tr_b16 v[160:161], v8 offset:36864
  ds_read_b64_tr_b16 v[162:163], v8 offset:37376
  v_mfma_f32_32x32x16_bf16 v[128:143], v[168:171], v[68:71], v[128:143]
  ds_read_b64_tr_b16 v[164:165], v8 offset:38912
  ds_read_b64_tr_b16 v[166:167], v8 offset:39424
  s_waitcnt lgkmcnt(8)
  v_mfma_f32_32x32x16_bf16 v[128:143], v[144:147], v[72:75], v[128:143]
  ds_read_b64_tr_b16 v[168:169], v8 offset:40960
  ds_read_b64_tr_b16 v[170:171], v8 offset:41472
  v_mfma_f32_32x32x16_bf16 v[128:143], v[148:151], v[76:79], v[128:143]
  ds_read_b64_tr_b16 v[144:145], v8 offset:43008
  ds_read_b64_tr_b16 v[146:147], v8 offset:43520
  s_waitcnt lgkmcnt(8)
  v_mfma_f32_32x32x16_bf16 v[128:143], v[152:155], v[80:83], v[128:143]
  ds_read_b128 v[200:203], v9 offset:0
  ds_read_b128 v[204:207], v9 offset:16
  ds_read_b128 v[228:231], v10 offset:5120
  ds_read_b64_tr_b16 v[148:149], v8 offset:45056
  ds_read_b64_tr_b16 v[150:151], v8 offset:45568
  v_mfma_f32_32x32x16_bf16 v[128:143], v[156:159], v[84:87], v[128:143]
  ds_read_b64_tr_b16 v[152:153], v8 offset:47104
  ds_read_b64_tr_b16 v[154:155], v8 offset:47616
  s_waitcnt lgkmcnt(11)
  v_mfma_f32_32x32x16_bf16 v[128:143], v[160:163], v[88:91], v[128:143]
  ds_read_b64_tr_b16 v[156:157], v8 offset:49152
  ds_read_b64_tr_b16 v[158:159], v8 offset:49664
  v_mfma_f32_32x32x16_bf16 v[128:143], v[164:167], v[92:95], v[128:143]
  ds_read_b64_tr_b16 v[160:161], v8 offset:51200
  ds_read_b64_tr_b16 v[162:163], v8 offset:51712
  s_waitcnt lgkmcnt(11)
  v_mfma_f32_32x32x16_bf16 v[128:143], v[168:171], v[96:99], v[128:143]
  ds_read_b64_tr_b16 v[164:165], v8 offset:53248
  ds_read_b64_tr_b16 v[166:167], v8 offset:53760
  v_mfma_f32_32x32x16_bf16 v[128:143], v[144:147], v[100:103], v[128:143]
  ds_read_b64_tr_b16 v[168:169], v8 offset:55296
  ds_read_b64_tr_b16 v[170:171], v8 offset:55808
  s_waitcnt lgkmcnt(8)
  v_mfma_f32_32x32x16_bf16 v[128:143], v[148:151], v[104:107], v[128:143]
  v_add_f32 v200, v200, v201
  v_add_f32 v202, v202, v203
  v_add_f32 v204, v204, v205
  v_mfma_f32_32x32x16_bf16 v[128:143], v[152:155], v[108:111], v[128:143]
  v_add_f32 v206, v206, v207
  v_add_f32 v200, v200, v202
  v_add_f32 v204, v204, v206
  s_waitcnt lgkmcnt(4)
  v_mfma_f32_32x32x16_bf16 v[128:143], v[156:159], v[112:115], v[128:143]
  v_add_f32 v200, v200, v204
  v_cvt_pk_bf16_f32 v193, v200, v200
  v_lshlrev_b32 v201, 16, v193
  v_mfma_f32_32x32x16_bf16 v[128:143], v[160:163], v[116:119], v[128:143]
  v_sub_f32 v201, v200, v201
  v_cvt_pk_bf16_f32 v192, v200, v201
  s_waitcnt lgkmcnt(0)
  v_mfma_f32_32x32x16_bf16 v[128:143], v[164:167], v[120:123], v[128:143]
  v_mfma_f32_32x32x16_bf16 v[128:143], v[168:171], v[124:127], v[128:143]
  v_mfma_f32_32x32x16_bf16 v[128:143], v[192:195], v[188:191], v[128:143]
  s_branch K1_MF_DONE
K1_MF_D:
  s_waitcnt lgkmcnt(8)
  v_mfma_f32_32x32x16_bf16 v[128:143], v[16:19], v[144:147], 0
  ds_read_b64_tr_b16 v[168:169], v8 offset:12288
  ds_read_b64_tr_b16 v[170:171], v8 offset:12800
  v_mfma_f32_32x32x16_bf16 v[128:143], v[20:23], v[148:151], v[128:143]
  ds_read_b64_tr_b16 v[144:145], v8 offset:14336
  ds_read_b64_tr_b16 v[146:147], v8 offset:14848
  s_waitcnt lgkmcnt(8)
  v_mfma_f32_32x32x16_bf16 v[128:143], v[24:27], v[152:155], v[128:143]
  ds_read_b64_tr_b16 v[148:149], v8 offset:16384
  ds_read_b64_tr_b16 v[150:151], v8 offset:16896
  v_mfma_f32_32x32x16_bf16 v[128:143], v[28:31], v[156:159], v[128:143]
  ds_read_b64_tr_b16 v[152:153], v8 offset:18432
  ds_read_b64_tr_b16 v[154:155], v8 offset:18944
  s_waitcnt lgkmcnt(8)
  v_mfma_f32_32x32x16_bf16 v[128:143], v[32:35], v[160:163], v[128:143]
  ds_read_b64_tr_b16 v[156:157], v8 offset:20480
  ds_read_b64_tr_b16 v[158:159], v8 offset:20992
  v_mfma_f32_32x32x16_bf16 v[128:143], v[36:39], v[164:167], v[128:143]
  ds_read_b64_tr_b16 v[160:161], v8 offset:22528
  ds_read_b64_tr_b16 v[162:163], v8 offset:23040
  s_waitcnt lgkmcnt(8)
  v_mfma_f32_32x32x16_bf16 v[128:143], v[40:43], v[168:171], v[128:143]
  ds_read_b64_tr_b16 v[164:165], v8 offset:24576
  ds_read_b64_tr_b16 v[166:167], v8 offset:25088
  v_mfma_f32_32x32x16_bf16 v[128:143], v[44:47], v[144:147], v[128:143]
  ds_read_b64_tr_b16 v[168:169], v8 offset:26624
  ds_read_b64_tr_b16 v[170:171], v8 offset:27136
  s_waitcnt lgkmcnt(8)
  v_mfma_f32_32x32x16_bf16 v[128:143], v[48:51], v[148:151], v[128:143]
  ds_read_b64_tr_b16 v[144:145], v8 offset:28672
  ds_read_b64_tr_b16 v[146:147], v8 offset:29184
  v_mfma_f32_32x32x16_bf16 v[128:143], v[52:55], v[152:155], v[128:143]
  ds_read_b64_tr_b16 v[148:149], v8 offset:30720
  ds_read_b64_tr_b16 v[150:151], v8 offset:31232
  s_waitcnt lgkmcnt(8)
  v_mfma_f32_32x32x16_bf16 v[128:143], v[56:59], v[156:159], v[128:143]
  ds_read_b64_tr_b16 v[152:153], v8 offset:32768
  ds_read_b64_tr_b16 v[154:155], v8 offset:33280
  v_mfma_f32_32x32x16_bf16 v[128:143], v[60:63], v[160:163], v[128:143]
  ds_read_b64_tr_b16 v[156:157], v8 offset:34816
  ds_read_b64_tr_b16 v[158:159], v8 offset:35328
  s_waitcnt lgkmcnt(8)
  v_mfma_f32_32x32x16_bf16 v[128:143], v[64:67], v[164:167], v[128:143]
  ds_read_b64_tr_b16 v[160:161], v8 offset:36864
  ds_read_b64_tr_b16 v[162:163], v8 offset:37376
  v_mfma_f32_32x32x16_bf16 v[128:143], v[68:71], v[168:171], v[128:143]
  ds_read_b64_tr_b16 v[164:165], v8 offset:38912
  ds_read_b64_tr_b16 v[166:167], v8 offset:39424
  s_waitcnt lgkmcnt(8)
  v_mfma_f32_32x32x16_bf16 v[128:143], v[72:75], v[144:147], v[128:143]
  ds_read_b64_tr_b16 v[168:169], v8 offset:40960
  ds_read_b64_tr_b16 v[170:171], v8 offset:41472
  v_mfma_f32_32x32x16_bf16 v[128:143], v[76:79], v[148:151], v[128:143]
  ds_read_b64_tr_b16 v[144:145], v8 offset:43008
  ds_read_b64_tr_b16 v[146:147], v8 offset:43520
  s_waitcnt lgkmcnt(8)
  v_mfma_f32_32x32x16_bf16 v[128:143], v[80:83], v[152:155], v[128:143]
  ds_read_b128 v[200:203], v9 offset:0
  ds_read_b128 v[204:207], v9 offset:16
  ds_read_b128 v[228:231], v10 offset:5120
  ds_read_b64_tr_b16 v[148:149], v8 offset:45056
  ds_read_b64_tr_b16 v[150:151], v8 offset:45568
  v_mfma_f32_32x32x16_bf16 v[128:143], v[84:87], v[156:159], v[128:143]
  ds_read_b64_tr_b16 v[152:153], v8 offset:47104
  ds_read_b64_tr_b16 v[154:155], v8 offset:47616
  s_waitcnt lgkmcnt(11)
  v_mfma_f32_32x32x16_bf16 v[128:143], v[88:91], v[160:163], v[128:143]
  ds_read_b64_tr_b16 v[156:157], v8 offset:49152
  ds_read_b64_tr_b16 v[158:159], v8 offset:49664
  v_mfma_f32_32x32x16_bf16 v[128:143], v[92:95], v[164:167], v[128:143]
  ds_read_b64_tr_b16 v[160:161], v8 offset:51200
  ds_read_b64_tr_b16 v[162:163], v8 offset:51712
  s_waitcnt lgkmcnt(11)
  v_mfma_f32_32x32x16_bf16 v[128:143], v[96:99], v[168:171], v[128:143]
  ds_read_b64_tr_b16 v[164:165], v8 offset:53248
  ds_read_b64_tr_b16 v[166:167], v8 offset:53760
  v_mfma_f32_32x32x16_bf16 v[128:143], v[100:103], v[144:147], v[128:143]
  ds_read_b64_tr_b16 v[168:169], v8 offset:55296
  ds_read_b64_tr_b16 v[170:171], v8 offset:55808
  s_waitcnt lgkmcnt(8)
  v_mfma_f32_32x32x16_bf16 v[128:143], v[104:107], v[148:151], v[128:143]
  v_add_f32 v200, v200, v201
  v_add_f32 v202, v202, v203
  v_add_f32 v204, v204, v205
  v_mfma_f32_32x32x16_bf16 v[128:143], v[108:111], v[152:155], v[128:143]
  v_add_f32 v206, v206, v207
  v_add_f32 v200, v200, v202
  v_add_f32 v204, v204, v206
  s_waitcnt lgkmcnt(4)
  v_mfma_f32_32x32x16_bf16 v[128:143], v[112:115], v[156:159], v[128:143]
  v_add_f32 v200, v200, v204
  v_cvt_pk_bf16_f32 v193, v200, v200
  v_lshlrev_b32 v201, 16, v193
  v_mfma_f32_32x32x16_bf16 v[128:143], v[116:119], v[160:163], v[128:143]
  v_sub_f32 v201, v200, v201
  v_cvt_pk_bf16_f32 v192, v200, v201
  s_waitcnt lgkmcnt(0)
  v_mfma_f32_32x32x16_bf16 v[128:143], v[120:123], v[164:167], v[128:143]
  v_mfma_f32_32x32x16_bf16 v[128:143], v[124:127], v[168:171], v[128:143]
  v_mfma_f32_32x32x16_bf16 v[128:143], v[188:191], v[192:195], v[128:143]
K1_MF_DONE:
  s_setprio 0
  s_cmp_eq_u32 s34, 0
  s_cbranch_scc1 K1_E
  s_waitcnt vmcnt(4)
  s_cmp_eq_u32 s77, 4
  s_cbranch_scc1 K1_BW
  s_waitcnt vmcnt(2)
  s_cmp_eq_u32 s77, 2
  s_cbranch_scc1 K1_BW
  s_waitcnt vmcnt(0)
K1_BW:
  s_call_b64 s[72:73], K1_SYNC
K1_E:
  s_cmp_lg_u32 s37, 6
  s_cbranch_scc1 K1_E1
  s_lshl_b32 s46, s3, 4
  s_add_u32 s46, s46, s38
  s_cmp_lg_u32 s46, 2
  s_cbranch_scc1 K1_E0
  s_lshl_b32 s46, s32, 4
  v_mov_b32 v234, s46
  global_load_dword v234, v234, s[12:13] sc1
K1_E0:
  s_cmp_lg_u32 s38, 4
  s_cbranch_scc1 K1_E1
  v_mov_b32 v12, 5632
  ds_read_b32 v12, v12
  s_lshl_b32 s47, s32, 4
  v_mov_b32 v13, s47
  s_mul_i32 s46, s32, 28
  s_lshl_b32 s46, s46, 10
  s_lshl_b32 s47, s35, 8
  s_add_u32 s46, s46, s47
  s_add_u32 s46, s46, 23068672
  v_mul_u32_u24 v11, 14336, v3
  v_lshl_add_u32 v11, v2, 3, v11
  s_waitcnt lgkmcnt(0)
K1_POLL:
  v_readfirstlane_b32 s47, v12
  s_cmp_ge_u32 s47, 14
  s_cbranch_scc1 K1_LD
  s_sleep 2
  global_load_dword v12, v13, s[12:13] sc1
  s_waitcnt vmcnt(0)
  s_branch K1_POLL
K1_LD:
  buffer_load_dwordx2 v[16:17], v11, s[24:27], s46 offen offset:0 sc0 sc1
  buffer_load_dwordx2 v[18:19], v11, s[24:27], s46 offen offset:1024 sc0 sc1
  buffer_load_dwordx2 v[20:21], v11, s[24:27], s46 offen offset:2048 sc0 sc1
  buffer_load_dwordx2 v[22:23], v11, s[24:27], s46 offen offset:3072 sc0 sc1
  s_add_u32 s46, s46, 4096
  buffer_load_dwordx2 v[24:25], v11, s[24:27], s46 offen offset:0 sc0 sc1
  buffer_load_dwordx2 v[26:27], v11, s[24:27], s46 offen offset:1024 sc0 sc1
  buffer_load_dwordx2 v[28:29], v11, s[24:27], s46 offen offset:2048 sc0 sc1
  buffer_load_dwordx2 v[30:31], v11, s[24:27], s46 offen offset:3072 sc0 sc1
  s_add_u32 s46, s46, 4096
  buffer_load_dwordx2 v[32:33], v11, s[24:27], s46 offen offset:0 sc0 sc1
  buffer_load_dwordx2 v[34:35], v11, s[24:27], s46 offen offset:1024 sc0 sc1
  buffer_load_dwordx2 v[36:37], v11, s[24:27], s46 offen offset:2048 sc0 sc1
  buffer_load_dwordx2 v[38:39], v11, s[24:27], s46 offen offset:3072 sc0 sc1
  s_add_u32 s46, s46, 4096
  buffer_load_dwordx2 v[40:41], v11, s[24:27], s46 offen offset:0 sc0 sc1
  buffer_load_dwordx2 v[42:43], v11, s[24:27], s46 offen offset:1024 sc0 sc1
K1_E1:
  s_cmp_eq_u32 s57, 4
  s_cbranch_scc1 K1_EV
  s_cmp_ge_u32 s57, 2
  s_cbranch_scc1 K1_EQK
K1_EZ:
  s_mul_i32 s46, s36, 28
  s_add_u32 s46, s46, s58
  s_lshl_b32 s46, s46, 11
  s_add_u32 s46, s46, 6291456
  s_nop 1
  v_mul_f32 v212, v128, v128
  v_mul_f32 v213, v129, v129
  v_mul_f32 v214, v130, v130
  v_mul_f32 v215, v131, v131
  v_mul_f32 v216, v132, v132
  v_mul_f32 v217, v133, v133
  v_mul_f32 v218, v134, v134
  v_mul_f32 v219, v135, v135
  v_mul_f32 v220, v136, v136
  v_mul_f32 v221, v137, v137
  v_mul_f32 v222, v138, v138
  v_mul_f32 v223, v139, v139
  v_mul_f32 v224, v140, v140
  v_mul_f32 v225, v141, v141
  v_mul_f32 v226, v142, v142
  v_mul_f32 v227, v143, v143
  v_fma_f32 v212, v212, v252, v251
  v_fma_f32 v213, v213, v252, v251
  v_fma_f32 v214, v214, v252, v251
  v_fma_f32 v215, v215, v252, v251
  v_fma_f32 v216, v216, v252, v251
  v_fma_f32 v217, v217, v252, v251
  v_fma_f32 v218, v218, v252, v251
  v_fma_f32 v219, v219, v252, v251
  v_fma_f32 v220, v220, v252, v251
  v_fma_f32 v221, v221, v252, v251
  v_fma_f32 v222, v222, v252, v251
  v_fma_f32 v223, v223, v252, v251
  v_fma_f32 v224, v224, v252, v251
  v_fma_f32 v225, v225, v252, v251
  v_fma_f32 v226, v226, v252, v251
  v_fma_f32 v227, v227, v252, v251
  v_mul_f32 v212, v212, v128
  v_mul_f32 v213, v213, v129
  v_mul_f32 v214, v214, v130
  v_mul_f32 v215, v215, v131
  v_mul_f32 v216, v216, v132
  v_mul_f32 v217, v217, v133
  v_mul_f32 v218, v218, v134
  v_mul_f32 v219, v219, v135
  v_mul_f32 v220, v220, v136
  v_mul_f32 v221, v221, v137
  v_mul_f32 v222, v222, v138
  v_mul_f32 v223, v223, v139
  v_mul_f32 v224, v224, v140
  v_mul_f32 v225, v225, v141
  v_mul_f32 v226, v226, v142
  v_mul_f32 v227, v227, v143
  v_exp_f32 v212, v212
  v_exp_f32 v213, v213
  v_exp_f32 v214, v214
  v_exp_f32 v215, v215
  v_exp_f32 v216, v216
  v_exp_f32 v217, v217
  v_exp_f32 v218, v218
  v_exp_f32 v219, v219
  v_exp_f32 v220, v220
  v_exp_f32 v221, v221
  v_exp_f32 v222, v222
  v_exp_f32 v223, v223
  v_exp_f32 v224, v224
  v_exp_f32 v225, v225
  v_exp_f32 v226, v226
  v_exp_f32 v227, v227
  v_fma_f32 v212, v212, v253, v253
  v_fma_f32 v213, v213, v253, v253
  v_fma_f32 v214, v214, v253, v253
  v_fma_f32 v215, v215, v253, v253
  v_fma_f32 v216, v216, v253, v253
  v_fma_f32 v217, v217, v253, v253
  v_fma_f32 v218, v218, v253, v253
  v_fma_f32 v219, v219, v253, v253
  v_fma_f32 v220, v220, v253, v253
  v_fma_f32 v221, v221, v253, v253
  v_fma_f32 v222, v222, v253, v253
  v_fma_f32 v223, v223, v253, v253
  v_fma_f32 v224, v224, v253, v253
  v_fma_f32 v225, v225, v253, v253
  v_fma_f32 v226, v226, v253, v253
  v_fma_f32 v227, v227, v253, v253
  v_rcp_f32 v212, v212
  v_rcp_f32 v213, v213
  v_rcp_f32 v214, v214
  v_rcp_f32 v215, v215
  v_rcp_f32 v216, v216
  v_rcp_f32 v217, v217
  v_rcp_f32 v218, v218
  v_rcp_f32 v219, v219
  v_rcp_f32 v220, v220
  v_rcp_f32 v221, v221
  v_rcp_f32 v222, v222
  v_rcp_f32 v223, v223
  v_rcp_f32 v224, v224
  v_rcp_f32 v225, v225
  v_rcp_f32 v226, v226
  v_rcp_f32 v227, v227
  s_cmp_eq_u32 s57, 0
  s_cbranch_scc1 K1_EZ2
  v_mul_f32 v196, v128, v212
  v_mul_f32 v197, v129, v213
  v_mul_f32 v198, v130, v214
  v_mul_f32 v199, v131, v215
  v_mul_f32 v200, v132, v216
  v_mul_f32 v201, v133, v217
  v_mul_f32 v202, v134, v218
  v_mul_f32 v203, v135, v219
  v_mul_f32 v204, v136, v220
  v_mul_f32 v205, v137, v221
  v_mul_f32 v206, v138, v222
  v_mul_f32 v207, v139, v223
  v_mul_f32 v208, v140, v224
  v_mul_f32 v209, v141, v225
  v_mul_f32 v210, v142, v226
  v_mul_f32 v211, v143, v227
  v_cvt_pk_bf16_f32 v212, v196, v197
  v_cvt_pk_bf16_f32 v213, v198, v199
  v_cvt_pk_bf16_f32 v214, v200, v201
  v_cvt_pk_bf16_f32 v215, v202, v203
  v_cvt_pk_bf16_f32 v216, v204, v205
  v_cvt_pk_bf16_f32 v217, v206, v207
  v_cvt_pk_bf16_f32 v218, v208, v209
  v_cvt_pk_bf16_f32 v219, v210, v211
  buffer_store_dwordx4 v[212:215], v249, s[24:27], s46 offen sc1
  buffer_store_dwordx4 v[216:219], v249, s[24:27], s46 offen offset:1024 sc1
  s_mov_b32 s77, 2
  s_cmp_eq_u32 s76, 0
  s_cbranch_scc1 K1_EDONE
  s_waitcnt vmcnt(2)
  s_branch K1_EDONE
K1_EZ2:
  v_mul_f32 v172, v128, v212
  v_mul_f32 v173, v129, v213
  v_mul_f32 v174, v130, v214
  v_mul_f32 v175, v131, v215
  v_mul_f32 v176, v132, v216
  v_mul_f32 v177, v133, v217
  v_mul_f32 v178, v134, v218
  v_mul_f32 v179, v135, v219
  v_mul_f32 v180, v136, v220
  v_mul_f32 v181, v137, v221
  v_mul_f32 v182, v138, v222
  v_mul_f32 v183, v139, v223
  v_mul_f32 v184, v140, v224
  v_mul_f32 v185, v141, v225
  v_mul_f32 v186, v142, v226
  v_mul_f32 v187, v143, v227
  v_add_f32 v196, v172, v173
  v_mul_f32 v197, v172, v172
  v_add_f32 v198, v174, v175
  v_mul_f32 v199, v173, v173
  v_fmac_f32 v197, v174, v174
  v_fmac_f32 v199, v175, v175
  v_fmac_f32 v197, v176, v176
  v_add_f32 v196, v196, v176
  v_fmac_f32 v199, v177, v177
  v_add_f32 v198, v198, v177
  v_fmac_f32 v197, v178, v178
  v_add_f32 v196, v196, v178
  v_fmac_f32 v199, v179, v179
  v_add_f32 v198, v198, v179
  v_fmac_f32 v197, v180, v180
  v_add_f32 v196, v196, v180
  v_fmac_f32 v199, v181, v181
  v_add_f32 v198, v198, v181
  v_fmac_f32 v197, v182, v182
  v_add_f32 v196, v196, v182
  v_fmac_f32 v199, v183, v183
  v_add_f32 v198, v198, v183
  v_fmac_f32 v197, v184, v184
  v_add_f32 v196, v196, v184
  v_fmac_f32 v199, v185, v185
  v_add_f32 v198, v198, v185
  v_fmac_f32 v197, v186, v186
  v_add_f32 v196, v196, v186
  v_fmac_f32 v199, v187, v187
  v_add_f32 v198, v198, v187
  v_add_f32 v196, v196, v198
  v_add_f32 v197, v197, v199
  v_mov_b32 v198, v196
  v_mov_b32 v199, v197
  s_mov_b32 s59, s58
  s_mul_i32 s46, s32, 28
  v_permlane32_swap_b32 v196, v198
  v_permlane32_swap_b32 v197, v199
  s_add_u32 s46, s46, s58
  s_lshl_b32 s46, s46, 10
  v_add_f32 v196, v196, v198
  v_add_f32 v197, v197, v199
  s_lshl_b32 s47, s35, 8
  s_add_u32 s46, s46, s47
  s_add_u32 s46, s46, 23068672
  v_lshlrev_b32 v12, 3, v2
  s_mov_b32 exec_hi, 0
  buffer_store_dwordx2 v[196:197], v12, s[24:27], s46 offen sc0 sc1
  s_mov_b32 exec_hi, -1
  s_waitcnt vmcnt(1)
  s_branch K1_EDONE
K1_EQK:
  s_cmp_eq_u32 s57, 2
  s_cselect_b32 s46, 0x3e8b97f6, 1.0
  s_cselect_b32 s47, 0, 2097152
  v_mul_f32 v12, s46, v248
  s_lshl_b32 s46, s36, 11
  s_add_u32 s47, s47, s46
  v_add_u32 v228, v228, v250
  v_add_u32 v229, v229, v250
  v_add_u32 v230, v230, v250
  v_add_u32 v231, v231, v250
  v_mul_f32 v196, v128, v12
  v_mul_f32 v197, v129, v12
  v_mul_f32 v198, v130, v12
  v_mul_f32 v199, v131, v12
  v_mul_f32 v200, v132, v12
  v_mul_f32 v201, v133, v12
  v_mul_f32 v202, v134, v12
  v_mul_f32 v203, v135, v12
  v_mul_f32 v204, v136, v12
  v_mul_f32 v205, v137, v12
  v_mul_f32 v206, v138, v12
  v_mul_f32 v207, v139, v12
  v_mul_f32 v208, v140, v12
  v_mul_f32 v209, v141, v12
  v_mul_f32 v210, v142, v12
  v_mul_f32 v211, v143, v12
  v_cvt_pk_bf16_f32 v212, v196, v197
  v_cvt_pk_bf16_f32 v213, v198, v199
  v_cvt_pk_bf16_f32 v214, v200, v201
  v_cvt_pk_bf16_f32 v215, v202, v203
  v_cvt_pk_bf16_f32 v216, v204, v205
  v_cvt_pk_bf16_f32 v217, v206, v207
  v_cvt_pk_bf16_f32 v218, v208, v209
  v_cvt_pk_bf16_f32 v219, v210, v211
  buffer_store_dwordx2 v[212:213], v228, s[24:27], s47 offen sc1
  buffer_store_dwordx2 v[214:215], v229, s[24:27], s47 offen sc1
  buffer_store_dwordx2 v[216:217], v230, s[24:27], s47 offen sc1
  buffer_store_dwordx2 v[218:219], v231, s[24:27], s47 offen sc1
  s_mov_b32 s77, 4
  s_cmp_eq_u32 s76, 0
  s_cbranch_scc1 K1_EDONE
  s_waitcnt vmcnt(4)
  s_branch K1_EDONE
K1_EV:
  s_lshl_b32 s46, s35, 7
  v_lshl_add_u32 v12, v3, 4, s46
  ds_read_b128 v[212:215], v12 offset:4608
  ds_read_b128 v[216:219], v12 offset:4640
  ds_read_b128 v[220:223], v12 offset:4672
  ds_read_b128 v[224:227], v12 offset:4704
  s_lshl_b32 s46, s58, 5
  v_add_u32 v232, s46, v2
  v_mul_u32_u24 v233, 2341, v232
  v_lshrrev_b32 v233, 16, v233
  v_mul_u32_u24 v13, 28, v233
  v_sub_u32 v232, v232, v13
  v_lshl_add_u32 v13, v3, 5, v232
  v_lshlrev_b32 v13, 4, v13
  v_lshl_add_u32 v13, v233, 17, v13
  s_lshl_b32 s46, s36, 11
  s_add_u32 s46, s46, 4194304
  s_waitcnt lgkmcnt(0)
  v_mul_f32 v196, v128, v212
  v_mul_f32 v197, v129, v213
  v_mul_f32 v198, v130, v214
  v_mul_f32 v199, v131, v215
  v_mul_f32 v200, v132, v216
  v_mul_f32 v201, v133, v217
  v_mul_f32 v202, v134, v218
  v_mul_f32 v203, v135, v219
  v_mul_f32 v204, v136, v220
  v_mul_f32 v205, v137, v221
  v_mul_f32 v206, v138, v222
  v_mul_f32 v207, v139, v223
  v_mul_f32 v208, v140, v224
  v_mul_f32 v209, v141, v225
  v_mul_f32 v210, v142, v226
  v_mul_f32 v211, v143, v227
  v_cvt_pk_bf16_f32 v212, v196, v197
  v_cvt_pk_bf16_f32 v213, v198, v199
  v_cvt_pk_bf16_f32 v214, v200, v201
  v_cvt_pk_bf16_f32 v215, v202, v203
  v_cvt_pk_bf16_f32 v216, v204, v205
  v_cvt_pk_bf16_f32 v217, v206, v207
  v_cvt_pk_bf16_f32 v218, v208, v209
  v_cvt_pk_bf16_f32 v219, v210, v211
  buffer_store_dwordx4 v[212:215], v13, s[24:27], s46 offen sc1
  buffer_store_dwordx4 v[216:219], v13, s[24:27], s46 offen offset:1024 sc1
  s_mov_b32 s77, 2
  s_cmp_eq_u32 s76, 0
  s_cbranch_scc1 K1_EDONE
  s_waitcnt vmcnt(2)
K1_EDONE:
  s_lshl_b32 s46, s37, 4
  s_add_u32 s46, s46, s38
  s_cmp_eq_u32 s46, 0x64
  s_cbranch_scc1 K1_Z2A
  s_cmp_eq_u32 s46, 0x65
  s_cbranch_scc1 K1_Z2B
  s_cmp_ge_u32 s38, 5
  s_cbranch_scc1 K1_FIN
  s_cmp_eq_u32 s38, 3
  s_cbranch_scc1 K1_NEXT
  s_lshl_b32 s46, s3, 4
  s_add_u32 s46, s46, s38
  s_cmp_lg_u32 s46, 2
  s_cbranch_scc1 K1_NOFLG
  v_mov_b32 v12, 5632
  ds_write_b32 v12, v234
K1_NOFLG:
  s_call_b64 s[72:73], K1_SYNC
K1_NEXT:
  s_add_u32 s38, s38, 2
  s_mov_b32 s28, s29
  s_mov_b32 s29, s30
  s_mov_b32 s30, s31
  s_mov_b32 s31, -1
  s_xor_b32 s76, s34, 1
  s_cmp_eq_u32 s76, 1
  s_cbranch_scc0 K1_M
  s_setprio 1
  s_branch K1_M
K1_Z2A:
  s_lshl_b32 s46, s3, 11
  s_add_u32 s46, s46, 145408
  v_lshl_add_u32 v144, v2, 6, s46
  v_lshl_add_u32 v144, v3, 3, v144
  v_bfe_u32 v145, v1, 2, 2
  v_lshl_add_u32 v145, v3, 3, v145
  v_lshlrev_b32 v145, 6, v145
  v_bfe_u32 v146, v1, 4, 1
  v_lshl_add_u32 v145, v146, 5, v145
  v_and_b32 v146, 3, v1
  v_lshl_add_u32 v145, v146, 3, v145
  v_add_u32 v145, s46, v145
  s_mul_i32 s74, s36, 56
  s_add_u32 s74, s74, s59
  s_lshl_b32 s74, s74, 10
  s_add_u32 s74, s74, 10485760
  s_add_u32 s75, s74, 28672
  v_lshlrev_b32 v8, 1, v15
  v_add_u32 v8, 133120, v8
  v_add_f32 v16, v16, v30
  v_add_f32 v17, v17, v31
  v_add_f32 v18, v18, v32
  v_add_f32 v19, v19, v33
  v_add_f32 v20, v20, v34
  v_add_f32 v21, v21, v35
  v_add_f32 v22, v22, v36
  v_add_f32 v23, v23, v37
  v_add_f32 v24, v24, v38
  v_add_f32 v25, v25, v39
  v_add_f32 v26, v26, v40
  v_add_f32 v27, v27, v41
  v_add_f32 v28, v28, v42
  v_add_f32 v29, v29, v43
  v_add_f32 v16, v16, v24
  v_add_f32 v17, v17, v25
  v_add_f32 v18, v18, v26
  v_add_f32 v19, v19, v27
  v_add_f32 v20, v20, v28
  v_add_f32 v21, v21, v29
  v_add_f32 v16, v16, v20
  v_add_f32 v17, v17, v21
  v_add_f32 v18, v18, v22
  v_add_f32 v19, v19, v23
  v_add_f32 v16, v16, v18
  v_add_f32 v17, v17, v19
  v_mov_b32 v18, v16
  v_mov_b32 v19, v17
  s_nop 1
  v_permlane32_swap_b32 v16, v18
  v_permlane32_swap_b32 v17, v19
  s_nop 1
  v_add_f32 v16, v16, v18
  v_add_f32 v17, v17, v19
  v_mul_f32 v16, 0x3a924925, v16
  v_mul_f32 v17, 0x3a924925, v17
  v_fma_f32 v17, -v16, v16, v17
  v_max_f32 v17, 0, v17
  v_add_f32 v17, 0x3727c5ac, v17
  v_rsq_f32 v198, v17
  s_nop 0
  v_mul_f32 v199, v16, v198
  v_sub_f32 v199, 0, v199
  ds_write_b64 v8, v[198:199]
  s_waitcnt lgkmcnt(0)
  s_barrier
  s_branch K1_Z2N
K1_Z2B:
  s_lshl_b32 s46, s3, 11
  s_add_u32 s46, s46, 145408
  v_lshl_add_u32 v144, v2, 6, s46
  v_lshl_add_u32 v144, v3, 3, v144
  v_bfe_u32 v145, v1, 2, 2
  v_lshl_add_u32 v145, v3, 3, v145
  v_lshlrev_b32 v145, 6, v145
  v_bfe_u32 v146, v1, 4, 1
  v_lshl_add_u32 v145, v146, 5, v145
  v_and_b32 v146, 3, v1
  v_lshl_add_u32 v145, v146, 3, v145
  v_add_u32 v145, s46, v145
  s_mul_i32 s74, s36, 56
  s_add_u32 s74, s74, s59
  s_lshl_b32 s74, s74, 10
  s_add_u32 s74, s74, 10485760
  s_add_u32 s75, s74, 28672
  v_lshlrev_b32 v8, 1, v15
  v_add_u32 v8, 133120, v8
  ds_read_b64 v[198:199], v8
  s_waitcnt lgkmcnt(0)
K1_Z2N:
  v_fma_f32 v172, v172, v198, v199
  v_fma_f32 v173, v173, v198, v199
  v_fma_f32 v174, v174, v198, v199
  v_fma_f32 v175, v175, v198, v199
  v_fma_f32 v176, v176, v198, v199
  v_fma_f32 v177, v177, v198, v199
  v_fma_f32 v178, v178, v198, v199
  v_fma_f32 v179, v179, v198, v199
  v_fma_f32 v180, v180, v198, v199
  v_fma_f32 v181, v181, v198, v199
  v_fma_f32 v182, v182, v198, v199
  v_fma_f32 v183, v183, v198, v199
  v_fma_f32 v184, v184, v198, v199
  v_fma_f32 v185, v185, v198, v199
  v_fma_f32 v186, v186, v198, v199
  v_fma_f32 v187, v187, v198, v199
  v_cvt_pk_bf16_f32 v204, v172, v173
  v_cvt_pk_bf16_f32 v205, v174, v175
  v_cvt_pk_bf16_f32 v206, v176, v177
  v_cvt_pk_bf16_f32 v207, v178, v179
  v_cvt_pk_bf16_f32 v208, v180, v181
  v_cvt_pk_bf16_f32 v209, v182, v183
  v_cvt_pk_bf16_f32 v210, v184, v185
  v_cvt_pk_bf16_f32 v211, v186, v187
  ds_write_b64 v144, v[204:205] offset:0
  ds_write_b64 v144, v[206:207] offset:16
  ds_write_b64 v144, v[208:209] offset:32
  ds_write_b64 v144, v[210:211] offset:48
  s_waitcnt lgkmcnt(0)
  ds_read_b64_tr_b16 v[196:197], v145
  ds_read_b64_tr_b16 v[198:199], v145 offset:256
  ds_read_b64_tr_b16 v[200:201], v145 offset:1024
  ds_read_b64_tr_b16 v[202:203], v145 offset:1280
  s_waitcnt lgkmcnt(2)
  buffer_store_dwordx4 v[196:199], v249, s[24:27], s74 offen
  s_waitcnt lgkmcnt(0)
  buffer_store_dwordx4 v[200:203], v249, s[24:27], s75 offen
K1_FIN:
K1_END:
  s_endpgm
K1_SYNC:
  s_cmp_eq_u32 s29, -1
  s_cbranch_scc1 K1_SY1
  s_bfe_u32 s46, s38, 0x10001
  s_xor_b32 s46, s46, 1
  s_mul_i32 s47, s46, 57344
  s_lshl_b32 s48, s67, 11
  s_add_u32 s47, s47, s48
  v_add_u32 v12, s47, v7
  v_xor_b32 v13, 64, v12
  s_lshl_b32 s46, s46, 11
  v_add_u32 v11, s46, v14
  ds_read_b64_tr_b16 v[144:145], v12 offset:0
  ds_read_b64_tr_b16 v[146:147], v12 offset:512
  ds_read_b64_tr_b16 v[148:149], v13 offset:0
  ds_read_b64_tr_b16 v[150:151], v13 offset:512
  ds_read_b64_tr_b16 v[152:153], v12 offset:2048
  ds_read_b64_tr_b16 v[154:155], v12 offset:2560
  ds_read_b64_tr_b16 v[156:157], v13 offset:2048
  ds_read_b64_tr_b16 v[158:159], v13 offset:2560
  ds_read_b64_tr_b16 v[160:161], v12 offset:4096
  ds_read_b64_tr_b16 v[162:163], v12 offset:4608
  ds_read_b64_tr_b16 v[164:165], v13 offset:4096
  ds_read_b64_tr_b16 v[166:167], v13 offset:4608
  s_mov_b32 s64, s30
  s_call_b64 s[42:43], K1_DSET
  s_waitcnt lgkmcnt(10)
  v_mfma_f32_16x16x32_bf16 v[240:243], v[236:239], v[144:147], 0
  s_waitcnt lgkmcnt(8)
  v_mfma_f32_16x16x32_bf16 v[244:247], v[236:239], v[148:151], 0
  s_waitcnt lgkmcnt(6)
  v_mfma_f32_16x16x32_bf16 v[240:243], v[236:239], v[152:155], v[240:243]
  s_waitcnt lgkmcnt(4)
  v_mfma_f32_16x16x32_bf16 v[244:247], v[236:239], v[156:159], v[244:247]
  s_waitcnt lgkmcnt(2)
  v_mfma_f32_16x16x32_bf16 v[240:243], v[236:239], v[160:163], v[240:243]
  s_waitcnt lgkmcnt(0)
  v_mfma_f32_16x16x32_bf16 v[244:247], v[236:239], v[164:167], v[244:247]
  s_cmp_eq_u32 s34, 1
  s_cbranch_scc1 K1_SY0
  s_sub_u32 s46, s68, s67
  s_lshl_b32 s46, s46, 11
  v_add_u32 v12, s46, v12
  v_add_u32 v13, s46, v13
  ds_read_b64_tr_b16 v[144:145], v12
  ds_read_b64_tr_b16 v[146:147], v12 offset:512
  ds_read_b64_tr_b16 v[148:149], v13
  ds_read_b64_tr_b16 v[150:151], v13 offset:512
  s_waitcnt lgkmcnt(2)
  v_mfma_f32_16x16x32_bf16 v[240:243], v[236:239], v[144:147], v[240:243]
  s_waitcnt lgkmcnt(0)
  v_mfma_f32_16x16x32_bf16 v[244:247], v[236:239], v[148:151], v[244:247]
K1_SY0:
  s_mov_b64 exec, 0xffff
  s_nop 6
  ds_write_b32 v11, v240 offset:0
  ds_write_b32 v11, v241 offset:512
  ds_write_b32 v11, v244 offset:1024
  ds_write_b32 v11, v245 offset:1536
  s_mov_b64 exec, -1
K1_SY1:
  s_cmp_gt_u32 s38, 1
  s_cbranch_scc1 K1_SY2
  s_cmp_lg_u32 s37, 6
  s_cbranch_scc1 K1_SY2
  s_waitcnt vmcnt(0)
K1_SY2:
  s_waitcnt lgkmcnt(0)
  s_barrier
  s_lshl_b32 s46, s3, 4
  s_add_u32 s46, s46, s38
  s_lshl_b32 s47, s37, 8
  s_add_u32 s46, s46, s47
  s_cmp_lg_u32 s46, 0x641
  s_cbranch_scc1 K1_SY3
  s_lshl_b32 s46, s32, 4
  v_mov_b32 v12, s46
  v_mov_b32 v13, 1
  s_mov_b64 exec, 1
  global_atomic_add v12, v13, s[12:13] sc1
  s_mov_b64 exec, -1
K1_SY3:
  s_cmp_eq_u32 s30, -1
  s_cbranch_scc1 K1_SY4
  s_bfe_u32 s46, s38, 0x10001
  s_mul_i32 s39, s46, 57344
  s_add_u32 s39, s39, 6144
  s_call_b64 s[42:43], K1_DMA
K1_SY4:
  s_mov_b32 s77, 0
  s_setpc_b64 s[72:73]
K1_DSET:
  s_and_b32 s66, s64, 7
  s_cmp_ge_u32 s66, 2
  s_cselect_b32 s20, s6, s8
  s_cselect_b32 s21, s7, s9
  s_mov_b32 s22, 1605632
  s_cselect_b32 s22, 1204224, s22
  s_movk_i32 s66, 3584
  s_cselect_b32 s66, 2688, s66
  s_lshl_b32 s41, s66, 3
  v_mad_u32_u24 v6, v4, s66, v5
  s_mul_i32 s40, s67, s41
  s_lshl_b32 s40, s40, 1
  s_lshr_b32 s65, s64, 16
  s_add_u32 s40, s40, s65
  s_setpc_b64 s[42:43]
K1_DMA:
  s_lshl_b32 s46, s67, 11
  s_add_u32 m0, s39, s46
  s_mov_b32 s50, 6
K1_DMAL:
  s_sub_u32 s50, s50, 2
  buffer_load_dwordx4 v6, s[20:23], s40 offen lds
  s_add_u32 m0, m0, 1024
  s_add_u32 s40, s40, s41
  buffer_load_dwordx4 v6, s[20:23], s40 offen lds
  s_add_u32 m0, m0, 1024
  s_add_u32 s40, s40, s41
  s_cmp_lg_u32 s50, 0
  s_cbranch_scc1 K1_DMAL
K1_DMX:
  s_cmp_eq_u32 s34, 1
  s_cbranch_scc1 K1_DMR
  s_lshl_b32 s46, s68, 11
  s_add_u32 m0, s39, s46
  s_mul_i32 s40, s68, s41
  s_lshl_b32 s40, s40, 1
  s_add_u32 s40, s40, s65
  buffer_load_dwordx4 v6, s[20:23], s40 offen lds
  s_add_u32 m0, m0, 1024
  s_add_u32 s40, s40, s41
  buffer_load_dwordx4 v6, s[20:23], s40 offen lds
K1_DMR:
  s_setpc_b64 s[42:43]
.p2align 4
K1_TAB:
  .long 0x07000000, 0x00000002, 0x00000001, 0xffffffff
  .long 0x07800100, 0x03800003, 0x00800101, 0xffffffff
  .long 0x08000200, 0x07000004, 0x01000201, 0xffffffff
  .long 0x08800300, 0x00800102, 0x01800301, 0xffffffff
  .long 0x09000400, 0x04000103, 0x02000401, 0xffffffff
  .long 0x09800500, 0x07800104, 0x02800501, 0xffffffff
  .long 0x0a000600, 0x01000202, 0x03000601, 0xffffffff
  .long 0x0a800700, 0x04800203, 0x03800701, 0xffffffff
  .long 0x0b000800, 0x08000204, 0x04000801, 0xffffffff
  .long 0x0b800900, 0x01800302, 0x04800901, 0xffffffff
  .long 0x0c000a00, 0x05000303, 0x08800304, 0xffffffff
  .long 0x0c800b00, 0x02000402, 0x05800403, 0xffffffff
  .long 0x0d000c00, 0x09000404, 0x02800502, 0xffffffff
  .long 0x0d800d00, 0x06000503, 0x09800504, 0xffffffff
  .long 0x05000a01, 0x03000602, 0x05800b01, 0x0a000604
  .long 0x06000c01, 0x06800603, 0x06800d01, 0x0a000614
.globl k2_kernel
.p2align 8
.type k2_kernel,@function
k2_kernel:
  s_cmp_ge_u32 s2, 256
  s_cbranch_scc1 K2_END
  s_load_dwordx4 s[4:7], s[0:1], 40
  s_load_dwordx2 s[8:9], s[0:1], 16
  s_load_dwordx2 s[10:11], s[0:1], 56
  s_load_dwordx2 s[14:15], s[0:1], 80
  v_lshrrev_b32 v1, 6, v0
  v_and_b32 v2, 31, v0
  v_readfirstlane_b32 s3, v1
  v_and_b32 v1, 63, v0
  v_bfe_u32 v3, v0, 5, 1
  v_lshlrev_b32 v4, 4, v1
  s_lshr_b32 s59, s3, 2
  s_and_b32 s3, s3, 3
  s_cmp_eq_u32 s59, 1
  s_cbranch_scc1 GM_START
  s_and_b32 s32, s2, 7
  s_lshl_b32 s32, s32, 1
  s_bfe_u32 s33, s2, 0x10003
  s_add_u32 s32, s32, s33
  s_lshr_b32 s33, s2, 4
  s_lshl_b32 s33, s33, 2
  s_and_b32 s46, s3, 1
  s_lshl_b32 s46, s46, 1
  s_add_u32 s33, s33, s46
  s_lshr_b32 s51, s3, 1
  s_add_u32 s33, s33, s51
  s_lshl_b32 s34, s32, 17
  s_lshl_b32 s35, s33, 11
  s_add_u32 s35, s35, s34
  s_xor_b32 s52, s35, 0x800
  s_lshl_b32 s36, s3, 11
  s_add_u32 s37, s34, s36
  s_add_u32 s37, s37, 2097152
  s_mov_b32 s44, 0x0fffffff
  s_mov_b32 s45, 0x0fffffff
  s_mov_b32 s50, 0
  s_lshl_b32 s53, s51, 12
  s_setprio 2
  s_waitcnt lgkmcnt(0)
  s_mov_b32 s24, s14
  s_and_b32 s25, s15, 0xffff
  s_mov_b32 s26, 25165824
  s_mov_b32 s27, 0x00020000
  buffer_load_dwordx4 v[8:11], v4, s[24:27], s35 offen
  buffer_load_dwordx4 v[12:15], v4, s[24:27], s35 offen offset:1024
  buffer_load_dwordx4 v[16:19], v4, s[24:27], s52 offen
  buffer_load_dwordx4 v[20:23], v4, s[24:27], s52 offen offset:1024
AT_START:
  s_lshr_b32 s54, s2, 4
  s_and_b32 s54, s54, 3
  s_mul_i32 s54, s54, 8192
  s_and_b32 s54, s54, 0x1ffff
  s_add_u32 s38, s37, s54
  s_lshr_b32 s56, s2, 4
  s_lshl_b32 s56, s56, 13
  s_mov_b32 s54, 0
  s_and_b32 s46, s56, 8192
  s_add_u32 s38, s37, s46
  s_add_u32 m0, s36, 0
  s_nop 0
  buffer_load_dwordx4 v4, s[24:27], s38 offen lds
  buffer_load_dwordx4 v4, s[24:27], s38 offen offset:1024 lds
  s_add_u32 m0, m0, 8192
  s_add_u32 s39, s38, 2097152
  s_mov_b64 exec, s[44:45]
  buffer_load_dwordx4 v4, s[24:27], s39 offen lds
  buffer_load_dwordx4 v4, s[24:27], s39 offen offset:1024 lds
  s_mov_b64 exec, -1
  v_cmp_eq_u32 vcc, 28, v2
  v_mov_b32 v112, 0x3f803f80
  v_mov_b32 v116, s50
  v_cndmask_b32 v112, 0, v112, vcc
  v_mov_b32 v117, 65536
  v_mov_b32 v113, v112
  v_mov_b32 v114, v112
  v_mov_b32 v115, v112
  v_add_u32 v5, s36, v4
  ds_write_b32 v117, v116
  s_not_b64 exec, s[44:45]
  ds_write_b128 v5, v[112:115] offset:8192
  ds_write_b128 v5, v[112:115] offset:9216
  ds_write_b128 v5, v[112:115] offset:24576
  ds_write_b128 v5, v[112:115] offset:25600
  ds_write_b128 v5, v[112:115] offset:40960
  ds_write_b128 v5, v[112:115] offset:41984
  ds_write_b128 v5, v[112:115] offset:57344
  ds_write_b128 v5, v[112:115] offset:58368
  s_mov_b64 exec, -1
  s_mov_b32 s40, 49152
  s_mov_b32 s41, -1
  v_mov_b32 v80, 0
  v_mov_b32 v81, 0
  v_mov_b32 v82, 0
  v_mov_b32 v83, 0
  v_mov_b32 v84, 0
  v_mov_b32 v85, 0
  v_mov_b32 v86, 0
  v_mov_b32 v87, 0
  v_mov_b32 v88, 0
  v_mov_b32 v89, 0
  v_mov_b32 v90, 0
  v_mov_b32 v91, 0
  v_mov_b32 v92, 0
  v_mov_b32 v93, 0
  v_mov_b32 v94, 0
  v_mov_b32 v95, 0
  v_mov_b32 v96, 0
  v_mov_b32 v97, 0
  v_mov_b32 v98, 0
  v_mov_b32 v99, 0
  v_mov_b32 v100, 0
  v_mov_b32 v101, 0
  v_mov_b32 v102, 0
  v_mov_b32 v103, 0
  v_mov_b32 v104, 0
  v_mov_b32 v105, 0
  v_mov_b32 v106, 0
  v_mov_b32 v107, 0
  v_mov_b32 v108, 0
  v_mov_b32 v109, 0
  v_mov_b32 v110, 0
  v_mov_b32 v111, 0
  v_mov_b32 v76, 0
  v_mov_b32 v36, 0
  v_mov_b32 v77, 0
  v_mov_b32 v37, 0
  v_mov_b32 v78, 0
  v_mov_b32 v38, 0
  v_mov_b32 v79, 0
  v_mov_b32 v39, 0
  v_add_u32 v5, s53, v4
  v_add_u32 v6, s53, v4
  s_mul_i32 s55, s33, 86016
  s_add_u32 s55, s55, 14680064
  s_mul_i32 s47, s32, 7
  v_add_u32 v112, s47, v3
  v_lshlrev_b32 v113, 4, v2
  v_add_u32 v114, 0, v112
  v_lshrrev_b32 v116, 1, v114
  v_lshl_add_u32 v116, v116, 9, v113
  v_and_b32 v114, 1, v114
  v_lshl_add_u32 v140, v114, 3, v116
  v_add_u32 v114, 2, v112
  v_lshrrev_b32 v116, 1, v114
  v_lshl_add_u32 v116, v116, 9, v113
  v_and_b32 v114, 1, v114
  v_lshl_add_u32 v141, v114, 3, v116
  v_add_u32 v114, 4, v112
  v_lshrrev_b32 v116, 1, v114
  v_lshl_add_u32 v116, v116, 9, v113
  v_and_b32 v114, 1, v114
  v_lshl_add_u32 v142, v114, 3, v116
  v_add_u32 v114, 6, v112
  v_lshrrev_b32 v116, 1, v114
  v_lshl_add_u32 v116, v116, 9, v113
  v_and_b32 v114, 1, v114
  v_lshl_add_u32 v143, v114, 3, v116
  s_waitcnt vmcnt(0) lgkmcnt(0)
  s_barrier
  s_add_u32 m0, s36, 16384
  s_add_u32 s54, s54, 8192
  s_add_u32 s46, s54, s56
  s_and_b32 s46, s46, 8192
  s_andn2_b32 s38, s54, 8192
  s_or_b32 s38, s38, s46
  s_add_u32 s38, s37, s38
  buffer_load_dwordx4 v4, s[24:27], s38 offen lds
  buffer_load_dwordx4 v4, s[24:27], s38 offen offset:1024 lds
  s_add_u32 m0, m0, 8192
  s_add_u32 s39, s38, 2097152
  s_mov_b64 exec, s[44:45]
  buffer_load_dwordx4 v4, s[24:27], s39 offen lds
  buffer_load_dwordx4 v4, s[24:27], s39 offen offset:1024 lds
  s_mov_b64 exec, -1
  s_add_u32 m0, s36, 32768
  s_add_u32 s54, s54, 8192
  s_add_u32 s46, s54, s56
  s_and_b32 s46, s46, 8192
  s_andn2_b32 s38, s54, 8192
  s_or_b32 s38, s38, s46
  s_add_u32 s38, s37, s38
  buffer_load_dwordx4 v4, s[24:27], s38 offen lds
  buffer_load_dwordx4 v4, s[24:27], s38 offen offset:1024 lds
  s_add_u32 m0, m0, 8192
  s_add_u32 s39, s38, 2097152
  s_mov_b64 exec, s[44:45]
  buffer_load_dwordx4 v4, s[24:27], s39 offen lds
  buffer_load_dwordx4 v4, s[24:27], s39 offen offset:1024 lds
  s_mov_b64 exec, -1
  s_add_u32 s54, s54, 8192
  s_add_u32 s46, s54, s56
  s_and_b32 s46, s46, 8192
  s_andn2_b32 s38, s54, 8192
  s_or_b32 s38, s38, s46
  s_add_u32 s38, s37, s38
  s_cmp_lg_u32 s50, 0
  s_cbranch_scc1 AT_HAVEM
  ds_read_b128 v[24:27], v4
  ds_read_b128 v[28:31], v4 offset:1024
  s_mov_b32 exec_lo, 0
  v_mov_b32 v14, 0
  v_mov_b32 v15, 0
  v_mov_b32 v22, 0
  v_mov_b32 v23, 0
  s_mov_b32 exec_lo, -1
  s_waitcnt lgkmcnt(0)
  s_nop 1
  v_mfma_f32_32x32x16_bf16 v[40:55], v[24:27], v[8:11], 0
  v_mfma_f32_32x32x16_bf16 v[56:71], v[24:27], v[16:19], 0
  v_mfma_f32_32x32x16_bf16 v[40:55], v[28:31], v[12:15], v[40:55]
  v_mfma_f32_32x32x16_bf16 v[56:71], v[28:31], v[20:23], v[56:71]
  s_nop 11
  v_max3_f32 v112, v40, v41, v42
  v_max3_f32 v112, v112, v43, v44
  v_max3_f32 v112, v112, v45, v46
  v_max3_f32 v112, v112, v47, v48
  v_max3_f32 v112, v112, v49, v50
  v_max3_f32 v112, v112, v51, v52
  v_max3_f32 v112, v112, v53, v54
  v_max_f32 v112, v112, v55
  v_add_f32 v112, 0x42800000, v112
  v_max3_f32 v120, v56, v57, v58
  v_max3_f32 v120, v120, v59, v60
  v_max3_f32 v120, v120, v61, v62
  v_max3_f32 v120, v120, v63, v64
  v_max3_f32 v120, v120, v65, v66
  v_max3_f32 v120, v120, v67, v68
  v_max3_f32 v120, v120, v69, v70
  v_max_f32 v120, v120, v71
  v_add_f32 v120, 0x42800000, v120
AT_SETM:
  v_mov_b32 v113, v112
  s_nop 1
  v_permlane32_swap_b32 v112, v113
  s_nop 1
  v_max_f32 v112, v112, v113
  v_sub_f32 v112, 0, v112
  v_cvt_pk_bf16_f32 v113, v112, v112
  v_lshlrev_b32 v114, 16, v113
  v_sub_f32 v114, v112, v114
  v_cvt_pk_bf16_f32 v115, v114, v114
  v_lshlrev_b32 v116, 16, v115
  v_sub_f32 v116, v114, v116
  s_mov_b32 exec_lo, 0
  v_cvt_pk_bf16_f32 v14, v112, v114
  v_cvt_pk_bf16_f32 v15, v116, 0
  s_mov_b32 exec_lo, -1
  v_mov_b32 v121, v120
  s_nop 1
  v_permlane32_swap_b32 v120, v121
  s_nop 1
  v_max_f32 v120, v120, v121
  v_sub_f32 v120, 0, v120
  v_cvt_pk_bf16_f32 v121, v120, v120
  v_lshlrev_b32 v122, 16, v121
  v_sub_f32 v122, v120, v122
  v_cvt_pk_bf16_f32 v123, v122, v122
  v_lshlrev_b32 v124, 16, v123
  v_sub_f32 v124, v122, v124
  s_mov_b32 exec_lo, 0
  v_cvt_pk_bf16_f32 v22, v120, v122
  v_cvt_pk_bf16_f32 v23, v124, 0
  s_mov_b32 exec_lo, -1
  s_cmp_eq_u32 s50, 1
  s_cbranch_scc0 AT_HAVEM
  s_mov_b32 s50, 2
  s_branch AT_START
AT_HAVEM:
  ds_read_b128 v[24:27], v5
  ds_read_b128 v[28:31], v5 offset:1024
  ds_read_b128 v[32:35], v5 offset:8192
  s_waitcnt lgkmcnt(0)
  v_mfma_f32_32x32x16_bf16 v[40:55], v[24:27], v[8:11], 0
  v_mfma_f32_32x32x16_bf16 v[40:55], v[28:31], v[12:15], v[40:55]
  s_nop 11
  s_branch AT_U0
AT_LOOP:
  s_add_u32 s41, s41, 1
  v_mov_b32 v5, v6
  v_add_u32 v6, 0x4000, v6
  v_and_b32 v6, 0xffff, v6
  s_cmp_lt_u32 s41, 13
  s_cselect_b32 s42, s38, 2146435072
  s_add_u32 m0, s36, s40
  s_add_u32 s54, s54, 8192
  s_add_u32 s46, s54, s56
  s_and_b32 s46, s46, 8192
  s_andn2_b32 s38, s54, 8192
  s_or_b32 s38, s38, s46
  s_add_u32 s38, s37, s38
  s_add_u32 s40, s40, 0x4000
  s_and_b32 s40, s40, 0xffff
  s_waitcnt vmcnt(4)
  s_barrier
  v_exp_f32 v40, v40
  v_exp_f32 v41, v41
  v_mfma_f32_32x32x16_bf16 v[96:111], v[36:39], v[76:79], v[96:111]
  ds_read_b128 v[36:39], v5 offset:11264
  v_exp_f32 v42, v42
  v_exp_f32 v43, v43
  v_cvt_pk_bf16_f32 v72, v40, v41
  v_cvt_pk_bf16_f32 v73, v42, v43
  v_exp_f32 v44, v44
  v_exp_f32 v45, v45
  v_mfma_f32_32x32x16_bf16 v[56:71], v[24:27], v[16:19], 0
  ds_read_b128 v[24:27], v6 offset:0
  buffer_load_dwordx4 v4, s[24:27], s42 offen lds
  buffer_load_dwordx4 v4, s[24:27], s42 offen offset:1024 lds
  v_exp_f32 v46, v46
  v_exp_f32 v47, v47
  v_cvt_pk_bf16_f32 v74, v44, v45
  v_cvt_pk_bf16_f32 v75, v46, v47
  v_exp_f32 v48, v48
  v_exp_f32 v49, v49
  v_mfma_f32_32x32x16_bf16 v[56:71], v[28:31], v[20:23], v[56:71]
  ds_read_b128 v[28:31], v6 offset:1024
  v_exp_f32 v50, v50
  v_exp_f32 v51, v51
  v_cvt_pk_bf16_f32 v76, v48, v49
  v_cvt_pk_bf16_f32 v77, v50, v51
  v_exp_f32 v52, v52
  v_exp_f32 v53, v53
  s_waitcnt lgkmcnt(3)
  v_mfma_f32_32x32x16_bf16 v[80:95], v[32:35], v[72:75], v[80:95]
  s_nop 0
  v_exp_f32 v54, v54
  v_exp_f32 v55, v55
  v_cvt_pk_bf16_f32 v78, v52, v53
  v_cvt_pk_bf16_f32 v79, v54, v55
  v_exp_f32 v56, v56
  v_exp_f32 v57, v57
  s_waitcnt lgkmcnt(0)
  v_mfma_f32_32x32x16_bf16 v[80:95], v[36:39], v[76:79], v[80:95]
  v_exp_f32 v58, v58
  v_exp_f32 v59, v59
  v_cvt_pk_bf16_f32 v72, v56, v57
  v_cvt_pk_bf16_f32 v73, v58, v59
  v_exp_f32 v60, v60
  v_exp_f32 v61, v61
  v_mfma_f32_32x32x16_bf16 v[40:55], v[24:27], v[8:11], 0
  s_add_u32 m0, m0, 8192
  s_add_u32 s39, s42, 2097152
  s_mov_b64 exec, s[44:45]
  buffer_load_dwordx4 v4, s[24:27], s39 offen lds
  buffer_load_dwordx4 v4, s[24:27], s39 offen offset:1024 lds
  s_mov_b64 exec, -1
  v_exp_f32 v62, v62
  v_exp_f32 v63, v63
  v_cvt_pk_bf16_f32 v74, v60, v61
  v_cvt_pk_bf16_f32 v75, v62, v63
  v_exp_f32 v64, v64
  v_exp_f32 v65, v65
  v_mfma_f32_32x32x16_bf16 v[40:55], v[28:31], v[12:15], v[40:55]
  v_exp_f32 v66, v66
  v_exp_f32 v67, v67
  v_cvt_pk_bf16_f32 v76, v64, v65
  v_cvt_pk_bf16_f32 v77, v66, v67
  v_exp_f32 v68, v68
  v_exp_f32 v69, v69
  v_mfma_f32_32x32x16_bf16 v[96:111], v[32:35], v[72:75], v[96:111]
  ds_read_b128 v[32:35], v6 offset:8192
  v_exp_f32 v70, v70
  v_exp_f32 v71, v71
  v_cvt_pk_bf16_f32 v78, v68, v69
  v_cvt_pk_bf16_f32 v79, v70, v71
  s_cmp_eq_u32 s41, 15
  s_cbranch_scc1 AT_DONE
AT_U0:
  v_exp_f32 v40, v40
  v_exp_f32 v41, v41
  v_mfma_f32_32x32x16_bf16 v[96:111], v[36:39], v[76:79], v[96:111]
  ds_read_b128 v[36:39], v6 offset:9216
  v_exp_f32 v42, v42
  v_exp_f32 v43, v43
  v_cvt_pk_bf16_f32 v72, v40, v41
  v_cvt_pk_bf16_f32 v73, v42, v43
  v_exp_f32 v44, v44
  v_exp_f32 v45, v45
  v_mfma_f32_32x32x16_bf16 v[56:71], v[24:27], v[16:19], 0
  ds_read_b128 v[24:27], v6 offset:2048
  v_exp_f32 v46, v46
  v_exp_f32 v47, v47
  v_cvt_pk_bf16_f32 v74, v44, v45
  v_cvt_pk_bf16_f32 v75, v46, v47
  v_exp_f32 v48, v48
  v_exp_f32 v49, v49
  v_mfma_f32_32x32x16_bf16 v[56:71], v[28:31], v[20:23], v[56:71]
  ds_read_b128 v[28:31], v6 offset:3072
  v_exp_f32 v50, v50
  v_exp_f32 v51, v51
  v_cvt_pk_bf16_f32 v76, v48, v49
  v_cvt_pk_bf16_f32 v77, v50, v51
  v_exp_f32 v52, v52
  v_exp_f32 v53, v53
  s_waitcnt lgkmcnt(3)
  v_mfma_f32_32x32x16_bf16 v[80:95], v[32:35], v[72:75], v[80:95]
  s_nop 0
  v_exp_f32 v54, v54
  v_exp_f32 v55, v55
  v_cvt_pk_bf16_f32 v78, v52, v53
  v_cvt_pk_bf16_f32 v79, v54, v55
  v_exp_f32 v56, v56
  v_exp_f32 v57, v57
  s_waitcnt lgkmcnt(0)
  v_mfma_f32_32x32x16_bf16 v[80:95], v[36:39], v[76:79], v[80:95]
  v_exp_f32 v58, v58
  v_exp_f32 v59, v59
  v_cvt_pk_bf16_f32 v72, v56, v57
  v_cvt_pk_bf16_f32 v73, v58, v59
  v_exp_f32 v60, v60
  v_exp_f32 v61, v61
  v_mfma_f32_32x32x16_bf16 v[40:55], v[24:27], v[8:11], 0
  v_exp_f32 v62, v62
  v_exp_f32 v63, v63
  v_cvt_pk_bf16_f32 v74, v60, v61
  v_cvt_pk_bf16_f32 v75, v62, v63
  v_exp_f32 v64, v64
  v_exp_f32 v65, v65
  v_mfma_f32_32x32x16_bf16 v[40:55], v[28:31], v[12:15], v[40:55]
  v_exp_f32 v66, v66
  v_exp_f32 v67, v67
  v_cvt_pk_bf16_f32 v76, v64, v65
  v_cvt_pk_bf16_f32 v77, v66, v67
  v_exp_f32 v68, v68
  v_exp_f32 v69, v69
  v_mfma_f32_32x32x16_bf16 v[96:111], v[32:35], v[72:75], v[96:111]
  ds_read_b128 v[32:35], v6 offset:10240
  v_exp_f32 v70, v70
  v_exp_f32 v71, v71
  v_cvt_pk_bf16_f32 v78, v68, v69
  v_cvt_pk_bf16_f32 v79, v70, v71
  s_branch AT_LOOP
AT_DONE:
  v_mfma_f32_32x32x16_bf16 v[96:111], v[36:39], v[76:79], v[96:111]
  s_lshl_b32 s46, s3, 12
  v_add_u32 v5, s46, v4
  v_xor_b32 v6, 0x2000, v5
  s_waitcnt vmcnt(0) lgkmcnt(0)
  s_barrier
  s_nop 7
  ds_write_b128 v5, v[96:99] offset:0
  ds_write_b128 v5, v[100:103] offset:1024
  ds_write_b128 v5, v[104:107] offset:2048
  ds_write_b128 v5, v[108:111] offset:3072
  s_waitcnt lgkmcnt(0)
  s_barrier
  ds_read_b128 v[40:43], v6 offset:0
  ds_read_b128 v[44:47], v6 offset:1024
  ds_read_b128 v[48:51], v6 offset:2048
  ds_read_b128 v[52:55], v6 offset:3072
  s_waitcnt lgkmcnt(0)
  v_add_f32 v80, v80, v40
  v_add_f32 v81, v81, v41
  v_add_f32 v82, v82, v42
  v_add_f32 v83, v83, v43
  v_add_f32 v84, v84, v44
  v_add_f32 v85, v85, v45
  v_add_f32 v86, v86, v46
  v_add_f32 v87, v87, v47
  v_add_f32 v88, v88, v48
  v_add_f32 v89, v89, v49
  v_add_f32 v90, v90, v50
  v_add_f32 v91, v91, v51
  v_add_f32 v92, v92, v52
  v_add_f32 v93, v93, v53
  v_add_f32 v94, v94, v54
  v_add_f32 v95, v95, v55
  v_max3_f32 v112, |v80|, |v81|, |v82|
  v_max3_f32 v112, v112, |v83|, |v84|
  v_max3_f32 v112, v112, |v85|, |v86|
  v_max3_f32 v112, v112, |v87|, |v88|
  v_max3_f32 v112, v112, |v89|, |v90|
  v_max3_f32 v112, v112, |v91|, |v92|
  v_max3_f32 v112, v112, |v93|, |v94|
  v_max_f32 v112, v112, |v95|
  v_add_f32 v113, v80, v81
  v_add_f32 v113, v113, v82
  v_add_f32 v113, v113, v83
  v_add_f32 v113, v113, v84
  v_add_f32 v113, v113, v85
  v_add_f32 v113, v113, v86
  v_add_f32 v113, v113, v87
  v_add_f32 v113, v113, v88
  v_add_f32 v113, v113, v89
  v_add_f32 v113, v113, v90
  v_add_f32 v113, v113, v91
  v_add_f32 v113, v113, v92
  v_add_f32 v113, v113, v93
  v_add_f32 v113, v113, v94
  v_add_f32 v113, v113, v95
  v_mov_b32 v114, v92
  v_mov_b32 v115, v92
  v_fma_f32 v112, v113, 0, v112
  s_nop 0
  v_permlane32_swap_b32 v114, v115
  v_mov_b32 v117, 65536
  v_mov_b32 v118, 1
  v_cmp_ngt_f32 vcc, 0x7b800000, v112
  s_mov_b64 s[46:47], vcc
  v_cmp_nlt_f32 vcc, 0x08800000, v115
  s_or_b64 s[46:47], vcc, s[46:47]
  s_cbranch_scc0 AT_OK1
  ds_write_b32 v117, v118
AT_OK1:
  v_rcp_f32 v115, v115
  s_nop 0
  v_mul_f32 v80, v80, v115
  v_mul_f32 v81, v81, v115
  v_mul_f32 v82, v82, v115
  v_mul_f32 v83, v83, v115
  v_mul_f32 v84, v84, v115
  v_mul_f32 v85, v85, v115
  v_mul_f32 v86, v86, v115
  v_mul_f32 v87, v87, v115
  v_mul_f32 v88, v88, v115
  v_mul_f32 v89, v89, v115
  v_mul_f32 v90, v90, v115
  v_mul_f32 v91, v91, v115
  v_mul_f32 v92, v92, v115
  v_mul_f32 v93, v93, v115
  v_mul_f32 v94, v94, v115
  v_mul_f32 v95, v95, v115
  v_cvt_pk_bf16_f32 v72, v80, v81
  v_cvt_pk_bf16_f32 v73, v82, v83
  v_cvt_pk_bf16_f32 v74, v84, v85
  v_cvt_pk_bf16_f32 v75, v86, v87
  v_cvt_pk_bf16_f32 v76, v88, v89
  v_cvt_pk_bf16_f32 v77, v90, v91
  v_cvt_pk_bf16_f32 v78, v92, v93
  v_cvt_pk_bf16_f32 v79, v94, v95
  buffer_store_dwordx2 v[72:73], v140, s[24:27], s55 offen
  buffer_store_dwordx2 v[74:75], v141, s[24:27], s55 offen
  buffer_store_dwordx2 v[76:77], v142, s[24:27], s55 offen
  s_mov_b32 exec_hi, 0
  buffer_store_dwordx2 v[78:79], v143, s[24:27], s55 offen
  s_mov_b32 exec_hi, -1
  s_waitcnt lgkmcnt(0)
  s_barrier
  ds_read_b32 v118, v117
  s_waitcnt lgkmcnt(0)
  v_readfirstlane_b32 s47, v118
  s_cmp_eq_u32 s47, 1
  s_cbranch_scc0 AT_STORE
  s_cmp_eq_u32 s50, 0
  s_cbranch_scc1 AT_SLOW
AT_STORE:
  s_endpgm
AT_SLOW:
  s_waitcnt vmcnt(0)
  s_mov_b32 s50, 1
  s_mov_b32 exec_lo, 0
  v_mov_b32 v14, 0
  v_mov_b32 v15, 0
  v_mov_b32 v22, 0
  v_mov_b32 v23, 0
  s_mov_b32 exec_lo, -1
  v_mov_b32 v112, 0xff800000
  v_mov_b32 v120, 0xff800000
  s_mov_b32 s38, s37
  s_mov_b32 s41, 0
AT_SL1:
  s_barrier
  s_mov_b32 m0, s36
  s_nop 0
  buffer_load_dwordx4 v4, s[24:27], s38 offen lds
  buffer_load_dwordx4 v4, s[24:27], s38 offen offset:1024 lds
  s_add_u32 s38, s38, 8192
  s_waitcnt vmcnt(0)
  s_barrier
  v_mov_b32 v5, v4
  s_mov_b32 s42, 0
AT_SL2:
  ds_read_b128 v[24:27], v5
  ds_read_b128 v[28:31], v5 offset:1024
  v_add_u32 v5, 0x800, v5
  s_waitcnt lgkmcnt(0)
  v_mfma_f32_32x32x16_bf16 v[40:55], v[24:27], v[8:11], 0
  v_mfma_f32_32x32x16_bf16 v[56:71], v[24:27], v[16:19], 0
  v_mfma_f32_32x32x16_bf16 v[40:55], v[28:31], v[12:15], v[40:55]
  v_mfma_f32_32x32x16_bf16 v[56:71], v[28:31], v[20:23], v[56:71]
  s_nop 15
  v_max3_f32 v112, v112, v40, v41
  v_max3_f32 v112, v112, v42, v43
  v_max3_f32 v112, v112, v44, v45
  v_max3_f32 v112, v112, v46, v47
  v_max3_f32 v112, v112, v48, v49
  v_max3_f32 v112, v112, v50, v51
  v_max3_f32 v112, v112, v52, v53
  v_max3_f32 v112, v112, v54, v55
  v_max3_f32 v120, v120, v56, v57
  v_max3_f32 v120, v120, v58, v59
  v_max3_f32 v120, v120, v60, v61
  v_max3_f32 v120, v120, v62, v63
  v_max3_f32 v120, v120, v64, v65
  v_max3_f32 v120, v120, v66, v67
  v_max3_f32 v120, v120, v68, v69
  v_max3_f32 v120, v120, v70, v71
  s_add_u32 s42, s42, 1
  s_cmp_lt_u32 s42, 4
  s_cbranch_scc1 AT_SL2
  s_add_u32 s41, s41, 1
  s_cmp_lt_u32 s41, 16
  s_cbranch_scc1 AT_SL1
  s_barrier
  s_branch AT_SETM
GM_START:
  s_and_b32 s32, s2, 7
  s_lshr_b32 s33, s2, 3
  s_lshr_b32 s34, s32, 1
  s_lshl_b32 s34, s34, 3
  s_bitcmp1_b32 s32, 0
  s_cbranch_scc1 GM_ODD
  s_lshr_b32 s35, s33, 2
  s_and_b32 s36, s33, 3
  s_branch GM_GO
GM_ODD:
  s_cmp_ge_u32 s33, 24
  s_cbranch_scc1 TR_START
  s_mul_i32 s35, s33, 43
  s_lshr_b32 s35, s35, 7
  s_mul_i32 s36, s35, 3
  s_sub_u32 s36, s33, s36
  s_add_u32 s36, s36, 4
GM_GO:
  s_add_u32 s35, s35, s34
  s_lshr_b32 s37, s3, 1
  s_and_b32 s38, s3, 1
  s_lshl_b32 s39, s36, 2
  s_lshl_b32 s46, s38, 1
  s_add_u32 s39, s39, s46
  s_mul_i32 s40, s37, 112
  s_add_u32 s40, s40, s39
  s_lshl_b32 s40, s40, 10
  s_add_u32 s40, s40, 10485760
  s_lshl_b32 s41, s35, 18
  s_lshl_b32 s46, s3, 2
  v_lshrrev_b32 v5, 4, v1
  v_add_u32 v5, s46, v5
  v_and_b32 v6, 15, v1
  v_xor_b32 v6, v6, v5
  v_lshlrev_b32 v6, 4, v6
  v_lshl_add_u32 v5, v5, 12, v6
  s_lshl_b32 s42, s3, 10
  s_add_u32 s42, s42, 66560
  s_lshl_b32 s46, s37, 3
  v_add_u32 v6, s46, v3
  v_and_b32 v7, 15, v2
  v_xor_b32 v6, v6, v7
  v_lshlrev_b32 v6, 4, v6
  v_lshl_add_u32 v6, v2, 8, v6
  s_lshl_b32 s46, s37, 13
  v_add_u32 v240, s46, v6
  v_xor_b32 v241, 32, v240
  v_xor_b32 v242, 64, v240
  v_xor_b32 v243, 0x60, v240
  v_xor_b32 v244, 0x2000, v240
  v_xor_b32 v245, 0x2000, v241
  v_xor_b32 v246, 0x2000, v242
  v_xor_b32 v247, 0x2000, v243
  v_add_u32 v240, 66560, v240
  v_add_u32 v241, 66560, v241
  v_add_u32 v242, 66560, v242
  v_add_u32 v243, 66560, v243
  v_add_u32 v244, 66560, v244
  v_add_u32 v245, 66560, v245
  v_add_u32 v246, 66560, v246
  v_add_u32 v247, 66560, v247
  s_waitcnt lgkmcnt(0)
  s_mov_b32 s24, s14
  s_and_b32 s25, s15, 0xffff
  s_mov_b32 s26, 25165824
  s_mov_b32 s27, 0x00020000
  s_mov_b32 s16, s4
  s_and_b32 s17, s5, 0xffff
  s_mov_b32 s18, 8388608
  s_mov_b32 s19, 0x00020000
  s_mov_b32 s20, s6
  s_and_b32 s21, s7, 0xffff
  s_mov_b32 s22, 4096
  s_mov_b32 s23, 0x00020000
  s_lshl_b32 s43, s35, 1
  s_add_u32 s43, s43, s37
  s_mul_i32 s46, s43, 28
  s_add_u32 s46, s46, s39
  s_lshl_b32 s46, s46, 11
  s_add_u32 s46, s46, 6291456
  s_lshl_b32 s47, s43, 6
  v_lshlrev_b32 v7, 1, v2
  s_mov_b32 s50, s46
  s_mov_b32 s51, s47
  s_mul_i32 s45, s35, 1
  s_mul_i32 s46, s36, 1
  s_add_u32 s45, s45, s46
  s_and_b32 s45, s45, 0
  s_and_b32 s46, s2, 1
  s_lshl_b32 s46, s46, 3
  s_add_u32 s45, s45, s46
  s_and_b32 s45, s45, 15
  s_add_u32 s52, s35, s36
  s_add_u32 s53, s45, s52
  s_and_b32 s53, s53, 1
  s_andn2_b32 s49, s45, 1
  s_or_b32 s53, s53, s49
  s_lshl_b32 s48, s53, 8
  s_add_u32 s48, s48, s41
  s_mul_i32 s49, s53, 229376
  s_add_u32 s49, s49, s40
  s_add_u32 s45, s45, 1
  s_and_b32 s45, s45, 15
  s_mov_b32 s47, s49
  buffer_load_dwordx4 v[16:19], v4, s[24:27], s47 offen offset:0
  buffer_load_dwordx4 v[20:23], v4, s[24:27], s47 offen offset:1024
  s_add_u32 s47, s47, 28672
  buffer_load_dwordx4 v[24:27], v4, s[24:27], s47 offen offset:0
  buffer_load_dwordx4 v[28:31], v4, s[24:27], s47 offen offset:1024
  s_add_u32 s47, s47, 28672
  buffer_load_dwordx4 v[32:35], v4, s[24:27], s47 offen offset:0
  buffer_load_dwordx4 v[36:39], v4, s[24:27], s47 offen offset:1024
  s_add_u32 s47, s47, 28672
  buffer_load_dwordx4 v[40:43], v4, s[24:27], s47 offen offset:0
  buffer_load_dwordx4 v[44:47], v4, s[24:27], s47 offen offset:1024
  s_add_u32 m0, s42, 0
  s_mov_b32 s46, s48
  buffer_load_dwordx4 v5, s[16:19], s46 offen lds
  s_add_u32 m0, m0, 4096
  s_add_u32 s46, s46, 0x10000
  buffer_load_dwordx4 v5, s[16:19], s46 offen lds
  s_add_u32 m0, m0, 4096
  s_add_u32 s46, s46, 0x10000
  buffer_load_dwordx4 v5, s[16:19], s46 offen lds
  s_add_u32 m0, m0, 4096
  s_add_u32 s46, s46, 0x10000
  buffer_load_dwordx4 v5, s[16:19], s46 offen lds
  s_barrier
  s_add_u32 s53, s45, s52
  s_and_b32 s53, s53, 1
  s_andn2_b32 s49, s45, 1
  s_or_b32 s53, s53, s49
  s_lshl_b32 s48, s53, 8
  s_add_u32 s48, s48, s41
  s_mul_i32 s49, s53, 229376
  s_add_u32 s49, s49, s40
  s_add_u32 s45, s45, 1
  s_and_b32 s45, s45, 15
  s_mov_b32 s47, s49
  buffer_load_dwordx4 v[48:51], v4, s[24:27], s47 offen offset:0
  buffer_load_dwordx4 v[52:55], v4, s[24:27], s47 offen offset:1024
  s_add_u32 s47, s47, 28672
  buffer_load_dwordx4 v[56:59], v4, s[24:27], s47 offen offset:0
  buffer_load_dwordx4 v[60:63], v4, s[24:27], s47 offen offset:1024
  s_add_u32 s47, s47, 28672
  buffer_load_dwordx4 v[64:67], v4, s[24:27], s47 offen offset:0
  buffer_load_dwordx4 v[68:71], v4, s[24:27], s47 offen offset:1024
  s_add_u32 s47, s47, 28672
  buffer_load_dwordx4 v[72:75], v4, s[24:27], s47 offen offset:0
  buffer_load_dwordx4 v[76:79], v4, s[24:27], s47 offen offset:1024
  s_add_u32 m0, s42, 16384
  s_mov_b32 s46, s48
  buffer_load_dwordx4 v5, s[16:19], s46 offen lds
  s_add_u32 m0, m0, 4096
  s_add_u32 s46, s46, 0x10000
  buffer_load_dwordx4 v5, s[16:19], s46 offen lds
  s_add_u32 m0, m0, 4096
  s_add_u32 s46, s46, 0x10000
  buffer_load_dwordx4 v5, s[16:19], s46 offen lds
  s_add_u32 m0, m0, 4096
  s_add_u32 s46, s46, 0x10000
  buffer_load_dwordx4 v5, s[16:19], s46 offen lds
  s_barrier
  v_mov_b32 v160, 0
  v_mov_b32 v161, 0
  v_mov_b32 v162, 0
  v_mov_b32 v163, 0
  v_mov_b32 v164, 0
  v_mov_b32 v165, 0
  v_mov_b32 v166, 0
  v_mov_b32 v167, 0
  v_mov_b32 v168, 0
  v_mov_b32 v169, 0
  v_mov_b32 v170, 0
  v_mov_b32 v171, 0
  v_mov_b32 v172, 0
  v_mov_b32 v173, 0
  v_mov_b32 v174, 0
  v_mov_b32 v175, 0
  v_mov_b32 v176, 0
  v_mov_b32 v177, 0
  v_mov_b32 v178, 0
  v_mov_b32 v179, 0
  v_mov_b32 v180, 0
  v_mov_b32 v181, 0
  v_mov_b32 v182, 0
  v_mov_b32 v183, 0
  v_mov_b32 v184, 0
  v_mov_b32 v185, 0
  v_mov_b32 v186, 0
  v_mov_b32 v187, 0
  v_mov_b32 v188, 0
  v_mov_b32 v189, 0
  v_mov_b32 v190, 0
  v_mov_b32 v191, 0
  v_mov_b32 v192, 0
  v_mov_b32 v193, 0
  v_mov_b32 v194, 0
  v_mov_b32 v195, 0
  v_mov_b32 v196, 0
  v_mov_b32 v197, 0
  v_mov_b32 v198, 0
  v_mov_b32 v199, 0
  v_mov_b32 v200, 0
  v_mov_b32 v201, 0
  v_mov_b32 v202, 0
  v_mov_b32 v203, 0
  v_mov_b32 v204, 0
  v_mov_b32 v205, 0
  v_mov_b32 v206, 0
  v_mov_b32 v207, 0
  v_mov_b32 v208, 0
  v_mov_b32 v209, 0
  v_mov_b32 v210, 0
  v_mov_b32 v211, 0
  v_mov_b32 v212, 0
  v_mov_b32 v213, 0
  v_mov_b32 v214, 0
  v_mov_b32 v215, 0
  v_mov_b32 v216, 0
  v_mov_b32 v217, 0
  v_mov_b32 v218, 0
  v_mov_b32 v219, 0
  v_mov_b32 v220, 0
  v_mov_b32 v221, 0
  v_mov_b32 v222, 0
  v_mov_b32 v223, 0
  s_mov_b32 s44, 0
  s_waitcnt vmcnt(12)
  s_barrier
  ds_read_b128 v[144:147], v240
  ds_read_b128 v[148:151], v244
GM_LOOP:
  s_add_u32 s53, s45, s52
  s_and_b32 s53, s53, 1
  s_andn2_b32 s49, s45, 1
  s_or_b32 s53, s53, s49
  s_lshl_b32 s48, s53, 8
  s_add_u32 s48, s48, s41
  s_mul_i32 s49, s53, 229376
  s_add_u32 s49, s49, s40
  s_add_u32 s45, s45, 1
  s_and_b32 s45, s45, 15
  s_cmp_lt_u32 s44, 14
  s_cselect_b32 s48, s48, 2146435072
  s_cselect_b32 s49, s49, 2146435072
  ds_read_b128 v[152:155], v241 offset:0
  ds_read_b128 v[156:159], v245 offset:0
  s_waitcnt lgkmcnt(2)
  v_mfma_f32_32x32x16_bf16 v[160:175], v[16:19], v[144:147], v[160:175]
  s_mov_b32 s47, s49
  buffer_load_dwordx4 v[80:83], v4, s[24:27], s47 offen offset:0
  v_mfma_f32_32x32x16_bf16 v[176:191], v[20:23], v[144:147], v[176:191]
  buffer_load_dwordx4 v[84:87], v4, s[24:27], s47 offen offset:1024
  v_mfma_f32_32x32x16_bf16 v[192:207], v[16:19], v[148:151], v[192:207]
  s_add_u32 s47, s47, 28672
  buffer_load_dwordx4 v[88:91], v4, s[24:27], s47 offen offset:0
  v_mfma_f32_32x32x16_bf16 v[208:223], v[20:23], v[148:151], v[208:223]
  ds_read_b128 v[144:147], v242 offset:0
  ds_read_b128 v[148:151], v246 offset:0
  s_waitcnt lgkmcnt(2)
  v_mfma_f32_32x32x16_bf16 v[160:175], v[24:27], v[152:155], v[160:175]
  buffer_load_dwordx4 v[92:95], v4, s[24:27], s47 offen offset:1024
  v_mfma_f32_32x32x16_bf16 v[176:191], v[28:31], v[152:155], v[176:191]
  s_add_u32 s47, s47, 28672
  buffer_load_dwordx4 v[96:99], v4, s[24:27], s47 offen offset:0
  v_mfma_f32_32x32x16_bf16 v[192:207], v[24:27], v[156:159], v[192:207]
  buffer_load_dwordx4 v[100:103], v4, s[24:27], s47 offen offset:1024
  v_mfma_f32_32x32x16_bf16 v[208:223], v[28:31], v[156:159], v[208:223]
  ds_read_b128 v[152:155], v243 offset:0
  ds_read_b128 v[156:159], v247 offset:0
  s_waitcnt lgkmcnt(2)
  v_mfma_f32_32x32x16_bf16 v[160:175], v[32:35], v[144:147], v[160:175]
  s_add_u32 s47, s47, 28672
  buffer_load_dwordx4 v[104:107], v4, s[24:27], s47 offen offset:0
  v_mfma_f32_32x32x16_bf16 v[176:191], v[36:39], v[144:147], v[176:191]
  buffer_load_dwordx4 v[108:111], v4, s[24:27], s47 offen offset:1024
  v_mfma_f32_32x32x16_bf16 v[192:207], v[32:35], v[148:151], v[192:207]
  v_mfma_f32_32x32x16_bf16 v[208:223], v[36:39], v[148:151], v[208:223]
  s_waitcnt vmcnt(8)
  s_barrier
  ds_read_b128 v[144:147], v240 offset:16384
  ds_read_b128 v[148:151], v244 offset:16384
  s_waitcnt lgkmcnt(2)
  v_mfma_f32_32x32x16_bf16 v[160:175], v[40:43], v[152:155], v[160:175]
  s_add_u32 m0, s42, 32768
  s_mov_b32 s46, s48
  buffer_load_dwordx4 v5, s[16:19], s46 offen lds
  v_mfma_f32_32x32x16_bf16 v[176:191], v[44:47], v[152:155], v[176:191]
  s_add_u32 m0, m0, 4096
  s_add_u32 s46, s46, 0x10000
  buffer_load_dwordx4 v5, s[16:19], s46 offen lds
  v_mfma_f32_32x32x16_bf16 v[192:207], v[40:43], v[156:159], v[192:207]
  s_add_u32 m0, m0, 4096
  s_add_u32 s46, s46, 0x10000
  buffer_load_dwordx4 v5, s[16:19], s46 offen lds
  v_mfma_f32_32x32x16_bf16 v[208:223], v[44:47], v[156:159], v[208:223]
  s_add_u32 m0, m0, 4096
  s_add_u32 s46, s46, 0x10000
  buffer_load_dwordx4 v5, s[16:19], s46 offen lds
  s_add_u32 s53, s45, s52
  s_and_b32 s53, s53, 1
  s_andn2_b32 s49, s45, 1
  s_or_b32 s53, s53, s49
  s_lshl_b32 s48, s53, 8
  s_add_u32 s48, s48, s41
  s_mul_i32 s49, s53, 229376
  s_add_u32 s49, s49, s40
  s_add_u32 s45, s45, 1
  s_and_b32 s45, s45, 15
  s_cmp_lt_u32 s44, 13
  s_cselect_b32 s48, s48, 2146435072
  s_cselect_b32 s49, s49, 2146435072
  ds_read_b128 v[152:155], v241 offset:16384
  ds_read_b128 v[156:159], v245 offset:16384
  s_waitcnt lgkmcnt(2)
  v_mfma_f32_32x32x16_bf16 v[160:175], v[48:51], v[144:147], v[160:175]
  s_mov_b32 s47, s49
  buffer_load_dwordx4 v[112:115], v4, s[24:27], s47 offen offset:0
  v_mfma_f32_32x32x16_bf16 v[176:191], v[52:55], v[144:147], v[176:191]
  buffer_load_dwordx4 v[116:119], v4, s[24:27], s47 offen offset:1024
  v_mfma_f32_32x32x16_bf16 v[192:207], v[48:51], v[148:151], v[192:207]
  s_add_u32 s47, s47, 28672
  buffer_load_dwordx4 v[120:123], v4, s[24:27], s47 offen offset:0
  v_mfma_f32_32x32x16_bf16 v[208:223], v[52:55], v[148:151], v[208:223]
  ds_read_b128 v[144:147], v242 offset:16384
  ds_read_b128 v[148:151], v246 offset:16384
  s_waitcnt lgkmcnt(2)
  v_mfma_f32_32x32x16_bf16 v[160:175], v[56:59], v[152:155], v[160:175]
  buffer_load_dwordx4 v[124:127], v4, s[24:27], s47 offen offset:1024
  v_mfma_f32_32x32x16_bf16 v[176:191], v[60:63], v[152:155], v[176:191]
  s_add_u32 s47, s47, 28672
  buffer_load_dwordx4 v[128:131], v4, s[24:27], s47 offen offset:0
  v_mfma_f32_32x32x16_bf16 v[192:207], v[56:59], v[156:159], v[192:207]
  buffer_load_dwordx4 v[132:135], v4, s[24:27], s47 offen offset:1024
  v_mfma_f32_32x32x16_bf16 v[208:223], v[60:63], v[156:159], v[208:223]
  ds_read_b128 v[152:155], v243 offset:16384
  ds_read_b128 v[156:159], v247 offset:16384
  s_waitcnt lgkmcnt(2)
  v_mfma_f32_32x32x16_bf16 v[160:175], v[64:67], v[144:147], v[160:175]
  s_add_u32 s47, s47, 28672
  buffer_load_dwordx4 v[136:139], v4, s[24:27], s47 offen offset:0
  v_mfma_f32_32x32x16_bf16 v[176:191], v[68:71], v[144:147], v[176:191]
  buffer_load_dwordx4 v[140:143], v4, s[24:27], s47 offen offset:1024
  v_mfma_f32_32x32x16_bf16 v[192:207], v[64:67], v[148:151], v[192:207]
  v_mfma_f32_32x32x16_bf16 v[208:223], v[68:71], v[148:151], v[208:223]
  s_waitcnt vmcnt(8)
  s_barrier
  ds_read_b128 v[144:147], v240 offset:32768
  ds_read_b128 v[148:151], v244 offset:32768
  s_waitcnt lgkmcnt(2)
  v_mfma_f32_32x32x16_bf16 v[160:175], v[72:75], v[152:155], v[160:175]
  s_add_u32 m0, s42, 49152
  s_mov_b32 s46, s48
  buffer_load_dwordx4 v5, s[16:19], s46 offen lds
  v_mfma_f32_32x32x16_bf16 v[176:191], v[76:79], v[152:155], v[176:191]
  s_add_u32 m0, m0, 4096
  s_add_u32 s46, s46, 0x10000
  buffer_load_dwordx4 v5, s[16:19], s46 offen lds
  v_mfma_f32_32x32x16_bf16 v[192:207], v[72:75], v[156:159], v[192:207]
  s_add_u32 m0, m0, 4096
  s_add_u32 s46, s46, 0x10000
  buffer_load_dwordx4 v5, s[16:19], s46 offen lds
  v_mfma_f32_32x32x16_bf16 v[208:223], v[76:79], v[156:159], v[208:223]
  s_add_u32 m0, m0, 4096
  s_add_u32 s46, s46, 0x10000
  buffer_load_dwordx4 v5, s[16:19], s46 offen lds
  s_add_u32 s53, s45, s52
  s_and_b32 s53, s53, 1
  s_andn2_b32 s49, s45, 1
  s_or_b32 s53, s53, s49
  s_lshl_b32 s48, s53, 8
  s_add_u32 s48, s48, s41
  s_mul_i32 s49, s53, 229376
  s_add_u32 s49, s49, s40
  s_add_u32 s45, s45, 1
  s_and_b32 s45, s45, 15
  s_cmp_lt_u32 s44, 12
  s_cselect_b32 s48, s48, 2146435072
  s_cselect_b32 s49, s49, 2146435072
  ds_read_b128 v[152:155], v241 offset:32768
  ds_read_b128 v[156:159], v245 offset:32768
  s_waitcnt lgkmcnt(2)
  v_mfma_f32_32x32x16_bf16 v[160:175], v[80:83], v[144:147], v[160:175]
  s_mov_b32 s47, s49
  buffer_load_dwordx4 v[16:19], v4, s[24:27], s47 offen offset:0
  v_mfma_f32_32x32x16_bf16 v[176:191], v[84:87], v[144:147], v[176:191]
  buffer_load_dwordx4 v[20:23], v4, s[24:27], s47 offen offset:1024
  v_mfma_f32_32x32x16_bf16 v[192:207], v[80:83], v[148:151], v[192:207]
  s_add_u32 s47, s47, 28672
  buffer_load_dwordx4 v[24:27], v4, s[24:27], s47 offen offset:0
  v_mfma_f32_32x32x16_bf16 v[208:223], v[84:87], v[148:151], v[208:223]
  ds_read_b128 v[144:147], v242 offset:32768
  ds_read_b128 v[148:151], v246 offset:32768
  s_waitcnt lgkmcnt(2)
  v_mfma_f32_32x32x16_bf16 v[160:175], v[88:91], v[152:155], v[160:175]
  buffer_load_dwordx4 v[28:31], v4, s[24:27], s47 offen offset:1024
  v_mfma_f32_32x32x16_bf16 v[176:191], v[92:95], v[152:155], v[176:191]
  s_add_u32 s47, s47, 28672
  buffer_load_dwordx4 v[32:35], v4, s[24:27], s47 offen offset:0
  v_mfma_f32_32x32x16_bf16 v[192:207], v[88:91], v[156:159], v[192:207]
  buffer_load_dwordx4 v[36:39], v4, s[24:27], s47 offen offset:1024
  v_mfma_f32_32x32x16_bf16 v[208:223], v[92:95], v[156:159], v[208:223]
  ds_read_b128 v[152:155], v243 offset:32768
  ds_read_b128 v[156:159], v247 offset:32768
  s_waitcnt lgkmcnt(2)
  v_mfma_f32_32x32x16_bf16 v[160:175], v[96:99], v[144:147], v[160:175]
  s_add_u32 s47, s47, 28672
  buffer_load_dwordx4 v[40:43], v4, s[24:27], s47 offen offset:0
  v_mfma_f32_32x32x16_bf16 v[176:191], v[100:103], v[144:147], v[176:191]
  buffer_load_dwordx4 v[44:47], v4, s[24:27], s47 offen offset:1024
  v_mfma_f32_32x32x16_bf16 v[192:207], v[96:99], v[148:151], v[192:207]
  v_mfma_f32_32x32x16_bf16 v[208:223], v[100:103], v[148:151], v[208:223]
  s_waitcnt vmcnt(8)
  s_barrier
  ds_read_b128 v[144:147], v240 offset:49152
  ds_read_b128 v[148:151], v244 offset:49152
  s_waitcnt lgkmcnt(2)
  v_mfma_f32_32x32x16_bf16 v[160:175], v[104:107], v[152:155], v[160:175]
  s_cmp_eq_u32 s44, 12
  s_cbranch_scc1 GM_SK20
  s_add_u32 m0, s42, 0
  s_mov_b32 s46, s48
  buffer_load_dwordx4 v5, s[16:19], s46 offen lds
GM_SK20:
  v_mfma_f32_32x32x16_bf16 v[176:191], v[108:111], v[152:155], v[176:191]
  s_cmp_eq_u32 s44, 12
  s_cbranch_scc1 GM_SK21
  s_add_u32 m0, m0, 4096
  s_add_u32 s46, s46, 0x10000
  buffer_load_dwordx4 v5, s[16:19], s46 offen lds
GM_SK21:
  v_mfma_f32_32x32x16_bf16 v[192:207], v[104:107], v[156:159], v[192:207]
  s_cmp_eq_u32 s44, 12
  s_cbranch_scc1 GM_SK22
  s_add_u32 m0, m0, 4096
  s_add_u32 s46, s46, 0x10000
  buffer_load_dwordx4 v5, s[16:19], s46 offen lds
GM_SK22:
  v_mfma_f32_32x32x16_bf16 v[208:223], v[108:111], v[156:159], v[208:223]
  s_cmp_eq_u32 s44, 12
  s_cbranch_scc1 GM_SK23
  s_add_u32 m0, m0, 4096
  s_add_u32 s46, s46, 0x10000
  buffer_load_dwordx4 v5, s[16:19], s46 offen lds
GM_SK23:
  s_add_u32 s53, s45, s52
  s_and_b32 s53, s53, 1
  s_andn2_b32 s49, s45, 1
  s_or_b32 s53, s53, s49
  s_lshl_b32 s48, s53, 8
  s_add_u32 s48, s48, s41
  s_mul_i32 s49, s53, 229376
  s_add_u32 s49, s49, s40
  s_add_u32 s45, s45, 1
  s_and_b32 s45, s45, 15
  s_cmp_lt_u32 s44, 11
  s_cselect_b32 s48, s48, 2146435072
  s_cselect_b32 s49, s49, 2146435072
  ds_read_b128 v[152:155], v241 offset:49152
  ds_read_b128 v[156:159], v245 offset:49152
  s_waitcnt lgkmcnt(2)
  v_mfma_f32_32x32x16_bf16 v[160:175], v[112:115], v[144:147], v[160:175]
  s_mov_b32 s47, s49
  buffer_load_dwordx4 v[48:51], v4, s[24:27], s47 offen offset:0
  v_mfma_f32_32x32x16_bf16 v[176:191], v[116:119], v[144:147], v[176:191]
  buffer_load_dwordx4 v[52:55], v4, s[24:27], s47 offen offset:1024
  v_mfma_f32_32x32x16_bf16 v[192:207], v[112:115], v[148:151], v[192:207]
  s_add_u32 s47, s47, 28672
  buffer_load_dwordx4 v[56:59], v4, s[24:27], s47 offen offset:0
  v_mfma_f32_32x32x16_bf16 v[208:223], v[116:119], v[148:151], v[208:223]
  ds_read_b128 v[144:147], v242 offset:49152
  ds_read_b128 v[148:151], v246 offset:49152
  s_waitcnt lgkmcnt(2)
  v_mfma_f32_32x32x16_bf16 v[160:175], v[120:123], v[152:155], v[160:175]
  buffer_load_dwordx4 v[60:63], v4, s[24:27], s47 offen offset:1024
  v_mfma_f32_32x32x16_bf16 v[176:191], v[124:127], v[152:155], v[176:191]
  s_add_u32 s47, s47, 28672
  buffer_load_dwordx4 v[64:67], v4, s[24:27], s47 offen offset:0
  v_mfma_f32_32x32x16_bf16 v[192:207], v[120:123], v[156:159], v[192:207]
  buffer_load_dwordx4 v[68:71], v4, s[24:27], s47 offen offset:1024
  v_mfma_f32_32x32x16_bf16 v[208:223], v[124:127], v[156:159], v[208:223]
  ds_read_b128 v[152:155], v243 offset:49152
  ds_read_b128 v[156:159], v247 offset:49152
  s_waitcnt lgkmcnt(2)
  v_mfma_f32_32x32x16_bf16 v[160:175], v[128:131], v[144:147], v[160:175]
  s_add_u32 s47, s47, 28672
  buffer_load_dwordx4 v[72:75], v4, s[24:27], s47 offen offset:0
  v_mfma_f32_32x32x16_bf16 v[176:191], v[132:135], v[144:147], v[176:191]
  buffer_load_dwordx4 v[76:79], v4, s[24:27], s47 offen offset:1024
  v_mfma_f32_32x32x16_bf16 v[192:207], v[128:131], v[148:151], v[192:207]
  v_mfma_f32_32x32x16_bf16 v[208:223], v[132:135], v[148:151], v[208:223]
  s_waitcnt vmcnt(8)
  s_barrier
  ds_read_b128 v[144:147], v240 offset:0
  ds_read_b128 v[148:151], v244 offset:0
  s_waitcnt lgkmcnt(2)
  v_mfma_f32_32x32x16_bf16 v[160:175], v[136:139], v[152:155], v[160:175]
  s_cmp_eq_u32 s44, 12
  s_cbranch_scc1 GM_SK30
  s_add_u32 m0, s42, 16384
  s_mov_b32 s46, s48
  buffer_load_dwordx4 v5, s[16:19], s46 offen lds
GM_SK30:
  v_mfma_f32_32x32x16_bf16 v[176:191], v[140:143], v[152:155], v[176:191]
  s_cmp_eq_u32 s44, 12
  s_cbranch_scc1 GM_SK31
  s_add_u32 m0, m0, 4096
  s_add_u32 s46, s46, 0x10000
  buffer_load_dwordx4 v5, s[16:19], s46 offen lds
GM_SK31:
  v_mfma_f32_32x32x16_bf16 v[192:207], v[136:139], v[156:159], v[192:207]
  s_cmp_eq_u32 s44, 12
  s_cbranch_scc1 GM_SK32
  s_add_u32 m0, m0, 4096
  s_add_u32 s46, s46, 0x10000
  buffer_load_dwordx4 v5, s[16:19], s46 offen lds
GM_SK32:
  v_mfma_f32_32x32x16_bf16 v[208:223], v[140:143], v[156:159], v[208:223]
  s_cmp_eq_u32 s44, 12
  s_cbranch_scc1 GM_SK33
  s_add_u32 m0, m0, 4096
  s_add_u32 s46, s46, 0x10000
  buffer_load_dwordx4 v5, s[16:19], s46 offen lds
GM_SK33:
  s_add_u32 s44, s44, 4
  s_cmp_lg_u32 s44, 12
  s_cbranch_scc1 GM_NOZ
  buffer_load_dwordx4 v[224:227], v4, s[24:27], s50 offen
  buffer_load_dwordx4 v[228:231], v4, s[24:27], s50 offen offset:1024
  buffer_load_dwordx4 v[232:235], v4, s[24:27], s50 offen offset:2048
  buffer_load_dwordx4 v[236:239], v4, s[24:27], s50 offen offset:3072
  buffer_load_ushort v248, v7, s[20:23], s51 offen
GM_NOZ:
  s_cmp_lt_u32 s44, 16
  s_cbranch_scc1 GM_LOOP
  s_lshl_b32 s46, s3, 13
  s_add_u32 s46, s46, 82944
  v_add_u32 v5, s46, v4
  s_xor_b32 s46, s3, 2
  s_lshl_b32 s46, s46, 13
  s_add_u32 s46, s46, 82944
  v_add_u32 v6, s46, v4
  s_nop 4
  ds_write_b128 v5, v[192:195] offset:0
  ds_write_b128 v5, v[196:199] offset:1024
  ds_write_b128 v5, v[200:203] offset:2048
  ds_write_b128 v5, v[204:207] offset:3072
  ds_write_b128 v5, v[208:211] offset:4096
  ds_write_b128 v5, v[212:215] offset:5120
  ds_write_b128 v5, v[216:219] offset:6144
  ds_write_b128 v5, v[220:223] offset:7168
  s_waitcnt vmcnt(0)
  v_lshlrev_b32 v248, 16, v248
  s_mul_i32 s46, s43, 84
  s_lshl_b32 s47, s39, 1
  s_add_u32 s46, s46, s47
  s_lshl_b32 s46, s46, 10
  s_add_u32 s46, s46, 14708736
  v_add_f32 v160, v160, v248
  v_add_f32 v161, v161, v248
  v_add_f32 v162, v162, v248
  v_add_f32 v163, v163, v248
  v_add_f32 v164, v164, v248
  v_add_f32 v165, v165, v248
  v_add_f32 v166, v166, v248
  v_add_f32 v167, v167, v248
  v_add_f32 v168, v168, v248
  v_add_f32 v169, v169, v248
  v_add_f32 v170, v170, v248
  v_add_f32 v171, v171, v248
  v_add_f32 v172, v172, v248
  v_add_f32 v173, v173, v248
  v_add_f32 v174, v174, v248
  v_add_f32 v175, v175, v248
  v_add_f32 v176, v176, v248
  v_add_f32 v177, v177, v248
  v_add_f32 v178, v178, v248
  v_add_f32 v179, v179, v248
  v_add_f32 v180, v180, v248
  v_add_f32 v181, v181, v248
  v_add_f32 v182, v182, v248
  v_add_f32 v183, v183, v248
  v_add_f32 v184, v184, v248
  v_add_f32 v185, v185, v248
  v_add_f32 v186, v186, v248
  v_add_f32 v187, v187, v248
  v_add_f32 v188, v188, v248
  v_add_f32 v189, v189, v248
  v_add_f32 v190, v190, v248
  v_add_f32 v191, v191, v248
  s_waitcnt lgkmcnt(0)
  s_barrier
  ds_read_b128 v[16:19], v6 offset:0
  ds_read_b128 v[20:23], v6 offset:1024
  ds_read_b128 v[24:27], v6 offset:2048
  ds_read_b128 v[28:31], v6 offset:3072
  ds_read_b128 v[32:35], v6 offset:4096
  ds_read_b128 v[36:39], v6 offset:5120
  ds_read_b128 v[40:43], v6 offset:6144
  ds_read_b128 v[44:47], v6 offset:7168
  v_lshlrev_b32 v80, 16, v224
  v_and_b32 v81, 0xffff0000, v224
  v_lshlrev_b32 v82, 16, v225
  v_and_b32 v83, 0xffff0000, v225
  v_lshlrev_b32 v84, 16, v226
  v_and_b32 v85, 0xffff0000, v226
  v_lshlrev_b32 v86, 16, v227
  v_and_b32 v87, 0xffff0000, v227
  v_lshlrev_b32 v88, 16, v228
  v_and_b32 v89, 0xffff0000, v228
  v_lshlrev_b32 v90, 16, v229
  v_and_b32 v91, 0xffff0000, v229
  v_lshlrev_b32 v92, 16, v230
  v_and_b32 v93, 0xffff0000, v230
  v_lshlrev_b32 v94, 16, v231
  v_and_b32 v95, 0xffff0000, v231
  v_lshlrev_b32 v96, 16, v232
  v_and_b32 v97, 0xffff0000, v232
  v_lshlrev_b32 v98, 16, v233
  v_and_b32 v99, 0xffff0000, v233
  v_lshlrev_b32 v100, 16, v234
  v_and_b32 v101, 0xffff0000, v234
  v_lshlrev_b32 v102, 16, v235
  v_and_b32 v103, 0xffff0000, v235
  v_lshlrev_b32 v104, 16, v236
  v_and_b32 v105, 0xffff0000, v236
  v_lshlrev_b32 v106, 16, v237
  v_and_b32 v107, 0xffff0000, v237
  v_lshlrev_b32 v108, 16, v238
  v_and_b32 v109, 0xffff0000, v238
  v_lshlrev_b32 v110, 16, v239
  v_and_b32 v111, 0xffff0000, v239
  s_waitcnt lgkmcnt(0)
  v_add_f32 v160, v160, v16
  v_add_f32 v161, v161, v17
  v_add_f32 v162, v162, v18
  v_add_f32 v163, v163, v19
  v_add_f32 v164, v164, v20
  v_add_f32 v165, v165, v21
  v_add_f32 v166, v166, v22
  v_add_f32 v167, v167, v23
  v_add_f32 v168, v168, v24
  v_add_f32 v169, v169, v25
  v_add_f32 v170, v170, v26
  v_add_f32 v171, v171, v27
  v_add_f32 v172, v172, v28
  v_add_f32 v173, v173, v29
  v_add_f32 v174, v174, v30
  v_add_f32 v175, v175, v31
  v_add_f32 v176, v176, v32
  v_add_f32 v177, v177, v33
  v_add_f32 v178, v178, v34
  v_add_f32 v179, v179, v35
  v_add_f32 v180, v180, v36
  v_add_f32 v181, v181, v37
  v_add_f32 v182, v182, v38
  v_add_f32 v183, v183, v39
  v_add_f32 v184, v184, v40
  v_add_f32 v185, v185, v41
  v_add_f32 v186, v186, v42
  v_add_f32 v187, v187, v43
  v_add_f32 v188, v188, v44
  v_add_f32 v189, v189, v45
  v_add_f32 v190, v190, v46
  v_add_f32 v191, v191, v47
  v_mul_f32 v160, v160, v80
  v_mul_f32 v161, v161, v81
  v_mul_f32 v162, v162, v82
  v_mul_f32 v163, v163, v83
  v_mul_f32 v164, v164, v84
  v_mul_f32 v165, v165, v85
  v_mul_f32 v166, v166, v86
  v_mul_f32 v167, v167, v87
  v_mul_f32 v168, v168, v88
  v_mul_f32 v169, v169, v89
  v_mul_f32 v170, v170, v90
  v_mul_f32 v171, v171, v91
  v_mul_f32 v172, v172, v92
  v_mul_f32 v173, v173, v93
  v_mul_f32 v174, v174, v94
  v_mul_f32 v175, v175, v95
  v_mul_f32 v176, v176, v96
  v_mul_f32 v177, v177, v97
  v_mul_f32 v178, v178, v98
  v_mul_f32 v179, v179, v99
  v_mul_f32 v180, v180, v100
  v_mul_f32 v181, v181, v101
  v_mul_f32 v182, v182, v102
  v_mul_f32 v183, v183, v103
  v_mul_f32 v184, v184, v104
  v_mul_f32 v185, v185, v105
  v_mul_f32 v186, v186, v106
  v_mul_f32 v187, v187, v107
  v_mul_f32 v188, v188, v108
  v_mul_f32 v189, v189, v109
  v_mul_f32 v190, v190, v110
  v_mul_f32 v191, v191, v111
  v_cvt_pk_bf16_f32 v16, v160, v161
  v_cvt_pk_bf16_f32 v17, v162, v163
  v_cvt_pk_bf16_f32 v18, v164, v165
  v_cvt_pk_bf16_f32 v19, v166, v167
  v_cvt_pk_bf16_f32 v20, v168, v169
  v_cvt_pk_bf16_f32 v21, v170, v171
  v_cvt_pk_bf16_f32 v22, v172, v173
  v_cvt_pk_bf16_f32 v23, v174, v175
  v_cvt_pk_bf16_f32 v24, v176, v177
  v_cvt_pk_bf16_f32 v25, v178, v179
  v_cvt_pk_bf16_f32 v26, v180, v181
  v_cvt_pk_bf16_f32 v27, v182, v183
  v_cvt_pk_bf16_f32 v28, v184, v185
  v_cvt_pk_bf16_f32 v29, v186, v187
  v_cvt_pk_bf16_f32 v30, v188, v189
  v_cvt_pk_bf16_f32 v31, v190, v191
  s_nop 1
  v_permlane32_swap_b32 v16, v18
  v_permlane32_swap_b32 v17, v19
  v_permlane32_swap_b32 v20, v22
  v_permlane32_swap_b32 v21, v23
  v_permlane32_swap_b32 v24, v26
  v_permlane32_swap_b32 v25, v27
  v_permlane32_swap_b32 v28, v30
  v_permlane32_swap_b32 v29, v31
  s_nop 1
  buffer_store_dwordx4 v[16:19], v4, s[24:27], s46 offen offset:0
  buffer_store_dwordx4 v[20:23], v4, s[24:27], s46 offen offset:1024
  buffer_store_dwordx4 v[24:27], v4, s[24:27], s46 offen offset:2048
  buffer_store_dwordx4 v[28:31], v4, s[24:27], s46 offen offset:3072
  s_endpgm
TR_START:
  s_add_u32 s35, s34, s33
  s_sub_u32 s35, s35, 24
  s_waitcnt lgkmcnt(0)
  s_mov_b32 s24, s14
  s_and_b32 s25, s15, 0xffff
  s_mov_b32 s26, 25165824
  s_mov_b32 s27, 0x00020000
  v_bfe_u32 v5, v1, 2, 2
  v_lshl_add_u32 v5, v3, 3, v5
  v_mul_u32_u24 v5, 896, v5
  v_bfe_u32 v6, v1, 4, 1
  v_lshl_add_u32 v5, v6, 5, v5
  v_and_b32 v6, 3, v1
  v_lshl_add_u32 v5, v6, 3, v5
  s_lshl_b32 s46, s3, 6
  s_add_u32 s46, s46, 66560
  v_add_u32 v5, s46, v5
  s_mov_b32 s19, 0x00020000
TR_L0:
  s_cmp_lt_u32 s35, 28
  s_cselect_b32 s16, s8, s10
  s_cselect_b32 s17, s9, s11
  s_mov_b32 s18, 802816
  s_cselect_b32 s18, 401408, s18
  s_cselect_b32 s46, 0, 28
  s_and_b32 s17, s17, 0xffff
  s_sub_u32 s46, s35, s46
  s_mul_i32 s46, s46, 14336
  s_lshl_b32 s47, s3, 10
  s_add_u32 s46, s46, s47
  s_add_u32 m0, s47, 66560
  s_mov_b32 s48, s3
  s_barrier
TR_L1:
  buffer_load_dwordx4 v4, s[16:19], s46 offen lds
  s_add_u32 m0, m0, 4096
  s_add_u32 s46, s46, 4096
  s_add_u32 s48, s48, 4
  s_cmp_lt_u32 s48, 14
  s_cbranch_scc1 TR_L1
  s_waitcnt vmcnt(0)
  s_barrier
  s_mul_i32 s46, s35, 14
  s_add_u32 s46, s46, s3
  s_lshl_b32 s46, s46, 10
  s_add_u32 s46, s46, 20971520
  s_mov_b32 s48, s3
  v_mov_b32 v6, v5
TR_L2:
  ds_read_b64_tr_b16 v[8:9], v6
  ds_read_b64_tr_b16 v[10:11], v6 offset:3584
  v_add_u32 v6, 0x100, v6
  s_waitcnt lgkmcnt(0)
  buffer_store_dwordx4 v[8:11], v4, s[24:27], s46 offen
  s_add_u32 s46, s46, 4096
  s_add_u32 s48, s48, 4
  s_cmp_lt_u32 s48, 14
  s_cbranch_scc1 TR_L2
  s_add_u32 s35, s35, 32
  s_cmp_lt_u32 s35, 84
  s_cbranch_scc1 TR_L0
  s_endpgm
K2_END:
  s_endpgm
.globl k3_kernel
.p2align 8
.type k3_kernel,@function
k3_kernel:
  s_cmp_ge_u32 s2, 224
  s_cbranch_scc1 K3_END
  s_load_dwordx2 s[4:5], s[0:1], 0
  s_load_dwordx2 s[6:7], s[0:1], 64
  s_load_dwordx2 s[14:15], s[0:1], 80
  v_lshrrev_b32 v1, 6, v0
  v_and_b32 v2, 31, v0
  v_readfirstlane_b32 s3, v1
  v_and_b32 v1, 63, v0
  v_bfe_u32 v3, v0, 5, 1
  v_lshlrev_b32 v4, 4, v1
  s_and_b32 s32, s2, 7
  s_lshr_b32 s33, s2, 3
  s_mul_i32 s34, s33, 37
  s_lshr_b32 s34, s34, 8
  s_mul_i32 s35, s34, 7
  s_sub_u32 s35, s33, s35
  s_lshl_b32 s32, s32, 2
  s_add_u32 s34, s34, s32
  s_lshr_b32 s36, s3, 1
  s_and_b32 s37, s3, 1
  s_mul_i32 s40, s34, 168
  s_mul_i32 s46, s3, 21
  s_add_u32 s40, s40, s46
  s_lshl_b32 s40, s40, 10
  s_add_u32 s40, s40, 14680064
  s_mul_i32 s47, s36, 86016
  s_add_u32 s41, s40, 86016
  s_sub_u32 s41, s41, s47
  s_add_u32 s40, s40, s47
  s_mul_i32 s42, s46, 14
  s_lshl_b32 s47, s35, 1
  s_add_u32 s42, s42, s47
  s_add_u32 s42, s42, s37
  s_lshl_b32 s42, s42, 10
  s_add_u32 s42, s42, 20971520
  s_xor_b32 s44, s42, 0x400
  v_mul_u32_u24 v7, 896, v2
  v_lshl_add_u32 v7, v3, 4, v7
  s_lshl_b32 s43, s34, 1
  s_add_u32 s43, s43, s36
  s_mul_i32 s43, s43, 28672
  s_lshl_b32 s47, s35, 7
  s_add_u32 s43, s43, s47
  s_lshl_b32 s47, s37, 6
  s_add_u32 s43, s43, s47
  s_waitcnt lgkmcnt(0)
  s_mov_b32 s24, s14
  s_and_b32 s25, s15, 0xffff
  s_mov_b32 s26, 25165824
  s_mov_b32 s27, 0x00020000
  s_mov_b32 s16, s4
  s_and_b32 s17, s5, 0xffff
  s_mov_b32 s18, 1835008
  s_mov_b32 s19, 0x00020000
  s_mov_b32 s20, s6
  s_and_b32 s21, s7, 0xffff
  s_mov_b32 s22, 1835008
  s_mov_b32 s23, 0x00020000
  s_movk_i32 s48, 14336
  s_movk_i32 s49, 1024
  buffer_load_dwordx4 v[8:11], v4, s[24:27], s42 offen
  s_add_u32 s42, s42, s48
  buffer_load_dwordx4 v[12:15], v4, s[24:27], s44 offen
  s_add_u32 s44, s44, s48
  buffer_load_dwordx4 v[16:19], v4, s[24:27], s40 offen
  s_add_u32 s40, s40, s49
  buffer_load_dwordx4 v[20:23], v4, s[24:27], s41 offen
  s_add_u32 s41, s41, s49
  buffer_load_dwordx4 v[24:27], v4, s[24:27], s42 offen
  s_add_u32 s42, s42, s48
  buffer_load_dwordx4 v[28:31], v4, s[24:27], s44 offen
  s_add_u32 s44, s44, s48
  buffer_load_dwordx4 v[32:35], v4, s[24:27], s40 offen
  s_add_u32 s40, s40, s49
  buffer_load_dwordx4 v[36:39], v4, s[24:27], s41 offen
  s_add_u32 s41, s41, s49
  buffer_load_dwordx4 v[40:43], v4, s[24:27], s42 offen
  s_add_u32 s42, s42, s48
  buffer_load_dwordx4 v[44:47], v4, s[24:27], s44 offen
  s_add_u32 s44, s44, s48
  buffer_load_dwordx4 v[48:51], v4, s[24:27], s40 offen
  s_add_u32 s40, s40, s49
  buffer_load_dwordx4 v[52:55], v4, s[24:27], s41 offen
  s_add_u32 s41, s41, s49
  buffer_load_dwordx4 v[56:59], v4, s[24:27], s42 offen
  s_add_u32 s42, s42, s48
  buffer_load_dwordx4 v[60:63], v4, s[24:27], s44 offen
  s_add_u32 s44, s44, s48
  buffer_load_dwordx4 v[64:67], v4, s[24:27], s40 offen
  s_add_u32 s40, s40, s49
  buffer_load_dwordx4 v[68:71], v4, s[24:27], s41 offen
  s_add_u32 s41, s41, s49
  buffer_load_dwordx4 v[72:75], v4, s[24:27], s42 offen
  s_add_u32 s42, s42, s48
  buffer_load_dwordx4 v[76:79], v4, s[24:27], s44 offen
  s_add_u32 s44, s44, s48
  buffer_load_dwordx4 v[80:83], v4, s[24:27], s40 offen
  s_add_u32 s40, s40, s49
  buffer_load_dwordx4 v[84:87], v4, s[24:27], s41 offen
  s_add_u32 s41, s41, s49
  s_waitcnt vmcnt(16)
  v_mfma_f32_32x32x16_bf16 v[184:199], v[8:11], v[16:19], 0
  buffer_load_dwordx4 v[88:91], v4, s[24:27], s42 offen
  s_add_u32 s42, s42, s48
  v_mfma_f32_32x32x16_bf16 v[200:215], v[12:15], v[16:19], 0
  buffer_load_dwordx4 v[92:95], v4, s[24:27], s44 offen
  s_add_u32 s44, s44, s48
  v_mfma_f32_32x32x16_bf16 v[216:231], v[8:11], v[20:23], 0
  buffer_load_dwordx4 v[96:99], v4, s[24:27], s40 offen
  s_add_u32 s40, s40, s49
  v_mfma_f32_32x32x16_bf16 v[232:247], v[12:15], v[20:23], 0
  buffer_load_dwordx4 v[100:103], v4, s[24:27], s41 offen
  s_add_u32 s41, s41, s49
  s_waitcnt vmcnt(16)
  v_mfma_f32_32x32x16_bf16 v[184:199], v[24:27], v[32:35], v[184:199]
  buffer_load_dwordx4 v[8:11], v4, s[24:27], s42 offen
  s_add_u32 s42, s42, s48
  v_mfma_f32_32x32x16_bf16 v[200:215], v[28:31], v[32:35], v[200:215]
  buffer_load_dwordx4 v[12:15], v4, s[24:27], s44 offen
  s_add_u32 s44, s44, s48
  v_mfma_f32_32x32x16_bf16 v[216:231], v[24:27], v[36:39], v[216:231]
  buffer_load_dwordx4 v[16:19], v4, s[24:27], s40 offen
  s_add_u32 s40, s40, s49
  v_mfma_f32_32x32x16_bf16 v[232:247], v[28:31], v[36:39], v[232:247]
  buffer_load_dwordx4 v[20:23], v4, s[24:27], s41 offen
  s_add_u32 s41, s41, s49
  s_waitcnt vmcnt(16)
  v_mfma_f32_32x32x16_bf16 v[184:199], v[40:43], v[48:51], v[184:199]
  buffer_load_dwordx4 v[24:27], v4, s[24:27], s42 offen
  s_add_u32 s42, s42, s48
  v_mfma_f32_32x32x16_bf16 v[200:215], v[44:47], v[48:51], v[200:215]
  buffer_load_dwordx4 v[28:31], v4, s[24:27], s44 offen
  s_add_u32 s44, s44, s48
  v_mfma_f32_32x32x16_bf16 v[216:231], v[40:43], v[52:55], v[216:231]
  buffer_load_dwordx4 v[32:35], v4, s[24:27], s40 offen
  s_add_u32 s40, s40, s49
  v_mfma_f32_32x32x16_bf16 v[232:247], v[44:47], v[52:55], v[232:247]
  buffer_load_dwordx4 v[36:39], v4, s[24:27], s41 offen
  s_add_u32 s41, s41, s49
  s_waitcnt vmcnt(16)
  v_mfma_f32_32x32x16_bf16 v[184:199], v[56:59], v[64:67], v[184:199]
  buffer_load_dwordx4 v[40:43], v4, s[24:27], s42 offen
  s_add_u32 s42, s42, s48
  v_mfma_f32_32x32x16_bf16 v[200:215], v[60:63], v[64:67], v[200:215]
  buffer_load_dwordx4 v[44:47], v4, s[24:27], s44 offen
  s_add_u32 s44, s44, s48
  v_mfma_f32_32x32x16_bf16 v[216:231], v[56:59], v[68:71], v[216:231]
  buffer_load_dwordx4 v[48:51], v4, s[24:27], s40 offen
  s_add_u32 s40, s40, s49
  v_mfma_f32_32x32x16_bf16 v[232:247], v[60:63], v[68:71], v[232:247]
  buffer_load_dwordx4 v[52:55], v4, s[24:27], s41 offen
  s_add_u32 s41, s41, s49
  s_waitcnt vmcnt(16)
  v_mfma_f32_32x32x16_bf16 v[184:199], v[72:75], v[80:83], v[184:199]
  buffer_load_dwordx4 v[56:59], v4, s[24:27], s42 offen
  s_add_u32 s42, s42, s48
  v_mfma_f32_32x32x16_bf16 v[200:215], v[76:79], v[80:83], v[200:215]
  buffer_load_dwordx4 v[60:63], v4, s[24:27], s44 offen
  s_add_u32 s44, s44, s48
  v_mfma_f32_32x32x16_bf16 v[216:231], v[72:75], v[84:87], v[216:231]
  buffer_load_dwordx4 v[64:67], v4, s[24:27], s40 offen
  s_add_u32 s40, s40, s49
  v_mfma_f32_32x32x16_bf16 v[232:247], v[76:79], v[84:87], v[232:247]
  buffer_load_dwordx4 v[68:71], v4, s[24:27], s41 offen
  s_add_u32 s41, s41, s49
  s_waitcnt vmcnt(16)
  v_mfma_f32_32x32x16_bf16 v[184:199], v[88:91], v[96:99], v[184:199]
  buffer_load_dwordx4 v[72:75], v4, s[24:27], s42 offen
  s_add_u32 s42, s42, s48
  v_mfma_f32_32x32x16_bf16 v[200:215], v[92:95], v[96:99], v[200:215]
  buffer_load_dwordx4 v[76:79], v4, s[24:27], s44 offen
  s_add_u32 s44, s44, s48
  v_mfma_f32_32x32x16_bf16 v[216:231], v[88:91], v[100:103], v[216:231]
  buffer_load_dwordx4 v[80:83], v4, s[24:27], s40 offen
  s_add_u32 s40, s40, s49
  v_mfma_f32_32x32x16_bf16 v[232:247], v[92:95], v[100:103], v[232:247]
  buffer_load_dwordx4 v[84:87], v4, s[24:27], s41 offen
  s_add_u32 s41, s41, s49
  s_waitcnt vmcnt(16)
  v_mfma_f32_32x32x16_bf16 v[184:199], v[8:11], v[16:19], v[184:199]
  buffer_load_dwordx4 v[88:91], v4, s[24:27], s42 offen
  s_add_u32 s42, s42, s48
  v_mfma_f32_32x32x16_bf16 v[200:215], v[12:15], v[16:19], v[200:215]
  buffer_load_dwordx4 v[92:95], v4, s[24:27], s44 offen
  s_add_u32 s44, s44, s48
  v_mfma_f32_32x32x16_bf16 v[216:231], v[8:11], v[20:23], v[216:231]
  buffer_load_dwordx4 v[96:99], v4, s[24:27], s40 offen
  s_add_u32 s40, s40, s49
  v_mfma_f32_32x32x16_bf16 v[232:247], v[12:15], v[20:23], v[232:247]
  buffer_load_dwordx4 v[100:103], v4, s[24:27], s41 offen
  s_add_u32 s41, s41, s49
  s_waitcnt vmcnt(16)
  v_mfma_f32_32x32x16_bf16 v[184:199], v[24:27], v[32:35], v[184:199]
  buffer_load_dwordx4 v[8:11], v4, s[24:27], s42 offen
  s_add_u32 s42, s42, s48
  v_mfma_f32_32x32x16_bf16 v[200:215], v[28:31], v[32:35], v[200:215]
  buffer_load_dwordx4 v[12:15], v4, s[24:27], s44 offen
  s_add_u32 s44, s44, s48
  v_mfma_f32_32x32x16_bf16 v[216:231], v[24:27], v[36:39], v[216:231]
  buffer_load_dwordx4 v[16:19], v4, s[24:27], s40 offen
  s_add_u32 s40, s40, s49
  v_mfma_f32_32x32x16_bf16 v[232:247], v[28:31], v[36:39], v[232:247]
  buffer_load_dwordx4 v[20:23], v4, s[24:27], s41 offen
  s_add_u32 s41, s41, s49
  s_waitcnt vmcnt(16)
  v_mfma_f32_32x32x16_bf16 v[184:199], v[40:43], v[48:51], v[184:199]
  buffer_load_dwordx4 v[24:27], v4, s[24:27], s42 offen
  s_add_u32 s42, s42, s48
  v_mfma_f32_32x32x16_bf16 v[200:215], v[44:47], v[48:51], v[200:215]
  buffer_load_dwordx4 v[28:31], v4, s[24:27], s44 offen
  s_add_u32 s44, s44, s48
  v_mfma_f32_32x32x16_bf16 v[216:231], v[40:43], v[52:55], v[216:231]
  buffer_load_dwordx4 v[32:35], v4, s[24:27], s40 offen
  s_add_u32 s40, s40, s49
  v_mfma_f32_32x32x16_bf16 v[232:247], v[44:47], v[52:55], v[232:247]
  buffer_load_dwordx4 v[36:39], v4, s[24:27], s41 offen
  s_add_u32 s41, s41, s49
  s_waitcnt vmcnt(16)
  v_mfma_f32_32x32x16_bf16 v[184:199], v[56:59], v[64:67], v[184:199]
  buffer_load_dwordx4 v[40:43], v4, s[24:27], s42 offen
  s_add_u32 s42, s42, s48
  v_mfma_f32_32x32x16_bf16 v[200:215], v[60:63], v[64:67], v[200:215]
  buffer_load_dwordx4 v[44:47], v4, s[24:27], s44 offen
  s_add_u32 s44, s44, s48
  v_mfma_f32_32x32x16_bf16 v[216:231], v[56:59], v[68:71], v[216:231]
  buffer_load_dwordx4 v[48:51], v4, s[24:27], s40 offen
  s_add_u32 s40, s40, s49
  v_mfma_f32_32x32x16_bf16 v[232:247], v[60:63], v[68:71], v[232:247]
  buffer_load_dwordx4 v[52:55], v4, s[24:27], s41 offen
  s_add_u32 s41, s41, s49
  s_waitcnt vmcnt(16)
  v_mfma_f32_32x32x16_bf16 v[184:199], v[72:75], v[80:83], v[184:199]
  buffer_load_dwordx4 v[56:59], v4, s[24:27], s42 offen
  s_add_u32 s42, s42, s48
  v_mfma_f32_32x32x16_bf16 v[200:215], v[76:79], v[80:83], v[200:215]
  buffer_load_dwordx4 v[60:63], v4, s[24:27], s44 offen
  s_add_u32 s44, s44, s48
  v_mfma_f32_32x32x16_bf16 v[216:231], v[72:75], v[84:87], v[216:231]
  buffer_load_dwordx4 v[64:67], v4, s[24:27], s40 offen
  s_add_u32 s40, s40, s49
  v_mfma_f32_32x32x16_bf16 v[232:247], v[76:79], v[84:87], v[232:247]
  buffer_load_dwordx4 v[68:71], v4, s[24:27], s41 offen
  s_add_u32 s41, s41, s49
  s_waitcnt vmcnt(16)
  v_mfma_f32_32x32x16_bf16 v[184:199], v[88:91], v[96:99], v[184:199]
  buffer_load_dwordx4 v[72:75], v4, s[24:27], s42 offen
  s_add_u32 s42, s42, s48
  v_mfma_f32_32x32x16_bf16 v[200:215], v[92:95], v[96:99], v[200:215]
  buffer_load_dwordx4 v[76:79], v4, s[24:27], s44 offen
  s_add_u32 s44, s44, s48
  v_mfma_f32_32x32x16_bf16 v[216:231], v[88:91], v[100:103], v[216:231]
  buffer_load_dwordx4 v[80:83], v4, s[24:27], s40 offen
  s_add_u32 s40, s40, s49
  v_mfma_f32_32x32x16_bf16 v[232:247], v[92:95], v[100:103], v[232:247]
  buffer_load_dwordx4 v[84:87], v4, s[24:27], s41 offen
  s_add_u32 s41, s41, s49
  s_waitcnt vmcnt(16)
  v_mfma_f32_32x32x16_bf16 v[184:199], v[8:11], v[16:19], v[184:199]
  buffer_load_dwordx4 v[88:91], v4, s[24:27], s42 offen
  s_add_u32 s42, s42, s48
  v_mfma_f32_32x32x16_bf16 v[200:215], v[12:15], v[16:19], v[200:215]
  buffer_load_dwordx4 v[92:95], v4, s[24:27], s44 offen
  s_add_u32 s44, s44, s48
  v_mfma_f32_32x32x16_bf16 v[216:231], v[8:11], v[20:23], v[216:231]
  buffer_load_dwordx4 v[96:99], v4, s[24:27], s40 offen
  s_add_u32 s40, s40, s49
  v_mfma_f32_32x32x16_bf16 v[232:247], v[12:15], v[20:23], v[232:247]
  buffer_load_dwordx4 v[100:103], v4, s[24:27], s41 offen
  s_add_u32 s41, s41, s49
  s_waitcnt vmcnt(16)
  v_mfma_f32_32x32x16_bf16 v[184:199], v[24:27], v[32:35], v[184:199]
  buffer_load_dwordx4 v[8:11], v4, s[24:27], s42 offen
  s_add_u32 s42, s42, s48
  v_mfma_f32_32x32x16_bf16 v[200:215], v[28:31], v[32:35], v[200:215]
  buffer_load_dwordx4 v[12:15], v4, s[24:27], s44 offen
  s_add_u32 s44, s44, s48
  v_mfma_f32_32x32x16_bf16 v[216:231], v[24:27], v[36:39], v[216:231]
  buffer_load_dwordx4 v[16:19], v4, s[24:27], s40 offen
  s_add_u32 s40, s40, s49
  v_mfma_f32_32x32x16_bf16 v[232:247], v[28:31], v[36:39], v[232:247]
  buffer_load_dwordx4 v[20:23], v4, s[24:27], s41 offen
  s_add_u32 s41, s41, s49
  s_waitcnt vmcnt(16)
  v_mfma_f32_32x32x16_bf16 v[184:199], v[40:43], v[48:51], v[184:199]
  buffer_load_dwordx4 v[24:27], v4, s[24:27], s42 offen
  s_add_u32 s42, s42, s48
  v_mfma_f32_32x32x16_bf16 v[200:215], v[44:47], v[48:51], v[200:215]
  buffer_load_dwordx4 v[28:31], v4, s[24:27], s44 offen
  s_add_u32 s44, s44, s48
  v_mfma_f32_32x32x16_bf16 v[216:231], v[40:43], v[52:55], v[216:231]
  buffer_load_dwordx4 v[32:35], v4, s[24:27], s40 offen
  s_add_u32 s40, s40, s49
  v_mfma_f32_32x32x16_bf16 v[232:247], v[44:47], v[52:55], v[232:247]
  buffer_load_dwordx4 v[36:39], v4, s[24:27], s41 offen
  s_add_u32 s41, s41, s49
  s_waitcnt vmcnt(16)
  v_mfma_f32_32x32x16_bf16 v[184:199], v[56:59], v[64:67], v[184:199]
  buffer_load_dwordx4 v[40:43], v4, s[24:27], s42 offen
  s_add_u32 s42, s42, s48
  v_mfma_f32_32x32x16_bf16 v[200:215], v[60:63], v[64:67], v[200:215]
  buffer_load_dwordx4 v[44:47], v4, s[24:27], s44 offen
  s_add_u32 s44, s44, s48
  v_mfma_f32_32x32x16_bf16 v[216:231], v[56:59], v[68:71], v[216:231]
  buffer_load_dwordx4 v[48:51], v4, s[24:27], s40 offen
  s_add_u32 s40, s40, s49
  v_mfma_f32_32x32x16_bf16 v[232:247], v[60:63], v[68:71], v[232:247]
  buffer_load_dwordx4 v[52:55], v4, s[24:27], s41 offen
  s_add_u32 s41, s41, s49
  s_waitcnt vmcnt(16)
  v_mfma_f32_32x32x16_bf16 v[184:199], v[72:75], v[80:83], v[184:199]
  v_mfma_f32_32x32x16_bf16 v[200:215], v[76:79], v[80:83], v[200:215]
  v_mfma_f32_32x32x16_bf16 v[216:231], v[72:75], v[84:87], v[216:231]
  v_mfma_f32_32x32x16_bf16 v[232:247], v[76:79], v[84:87], v[232:247]
  buffer_load_dwordx4 v[248:251], v7, s[16:19], s43 offen
  buffer_load_dwordx4 v[252:255], v7, s[16:19], s43 offen offset:32
  s_waitcnt vmcnt(14)
  v_mfma_f32_32x32x16_bf16 v[184:199], v[88:91], v[96:99], v[184:199]
  v_mfma_f32_32x32x16_bf16 v[200:215], v[92:95], v[96:99], v[200:215]
  v_mfma_f32_32x32x16_bf16 v[216:231], v[88:91], v[100:103], v[216:231]
  v_mfma_f32_32x32x16_bf16 v[232:247], v[92:95], v[100:103], v[232:247]
  s_waitcnt vmcnt(10)
  v_mfma_f32_32x32x16_bf16 v[184:199], v[8:11], v[16:19], v[184:199]
  v_mfma_f32_32x32x16_bf16 v[200:215], v[12:15], v[16:19], v[200:215]
  v_mfma_f32_32x32x16_bf16 v[216:231], v[8:11], v[20:23], v[216:231]
  v_mfma_f32_32x32x16_bf16 v[232:247], v[12:15], v[20:23], v[232:247]
  s_waitcnt vmcnt(6)
  v_mfma_f32_32x32x16_bf16 v[184:199], v[24:27], v[32:35], v[184:199]
  v_mfma_f32_32x32x16_bf16 v[200:215], v[28:31], v[32:35], v[200:215]
  v_mfma_f32_32x32x16_bf16 v[216:231], v[24:27], v[36:39], v[216:231]
  v_mfma_f32_32x32x16_bf16 v[232:247], v[28:31], v[36:39], v[232:247]
  s_waitcnt vmcnt(2)
  v_mfma_f32_32x32x16_bf16 v[184:199], v[40:43], v[48:51], v[184:199]
  v_mfma_f32_32x32x16_bf16 v[200:215], v[44:47], v[48:51], v[200:215]
  v_mfma_f32_32x32x16_bf16 v[216:231], v[40:43], v[52:55], v[216:231]
  v_mfma_f32_32x32x16_bf16 v[232:247], v[44:47], v[52:55], v[232:247]
  s_xor_b32 s46, s3, 1
  s_mul_i32 s46, s46, 12288
  v_add_u32 v8, s46, v4
  s_xor_b32 s46, s3, 2
  s_mul_i32 s46, s46, 12288
  v_add_u32 v9, s46, v4
  s_xor_b32 s46, s3, 3
  s_mul_i32 s46, s46, 12288
  v_add_u32 v10, s46, v4
  s_mul_i32 s46, s3, 12288
  v_add_u32 v11, s46, v4
  ds_write_b128 v8, v[200:203] offset:0
  ds_write_b128 v8, v[204:207] offset:1024
  ds_write_b128 v8, v[208:211] offset:2048
  ds_write_b128 v8, v[212:215] offset:3072
  ds_write_b128 v9, v[216:219] offset:4096
  ds_write_b128 v9, v[220:223] offset:5120
  ds_write_b128 v9, v[224:227] offset:6144
  ds_write_b128 v9, v[228:231] offset:7168
  ds_write_b128 v10, v[232:235] offset:8192
  ds_write_b128 v10, v[236:239] offset:9216
  ds_write_b128 v10, v[240:243] offset:10240
  ds_write_b128 v10, v[244:247] offset:11264
  s_waitcnt vmcnt(0)
  v_permlane32_swap_b32 v248, v250
  v_permlane32_swap_b32 v249, v251
  v_permlane32_swap_b32 v252, v254
  v_permlane32_swap_b32 v253, v255
  s_nop 1
  v_lshlrev_b32 v96, 16, v248
  v_and_b32 v97, 0xffff0000, v248
  v_lshlrev_b32 v98, 16, v249
  v_and_b32 v99, 0xffff0000, v249
  v_lshlrev_b32 v100, 16, v250
  v_and_b32 v101, 0xffff0000, v250
  v_lshlrev_b32 v102, 16, v251
  v_and_b32 v103, 0xffff0000, v251
  v_lshlrev_b32 v104, 16, v252
  v_and_b32 v105, 0xffff0000, v252
  v_lshlrev_b32 v106, 16, v253
  v_and_b32 v107, 0xffff0000, v253
  v_lshlrev_b32 v108, 16, v254
  v_and_b32 v109, 0xffff0000, v254
  v_lshlrev_b32 v110, 16, v255
  v_and_b32 v111, 0xffff0000, v255
  v_add_f32 v184, v184, v96
  v_add_f32 v185, v185, v97
  v_add_f32 v186, v186, v98
  v_add_f32 v187, v187, v99
  v_add_f32 v188, v188, v100
  v_add_f32 v189, v189, v101
  v_add_f32 v190, v190, v102
  v_add_f32 v191, v191, v103
  v_add_f32 v192, v192, v104
  v_add_f32 v193, v193, v105
  v_add_f32 v194, v194, v106
  v_add_f32 v195, v195, v107
  v_add_f32 v196, v196, v108
  v_add_f32 v197, v197, v109
  v_add_f32 v198, v198, v110
  v_add_f32 v199, v199, v111
  s_waitcnt lgkmcnt(0)
  s_barrier
  ds_read_b128 v[16:19], v11 offset:0
  ds_read_b128 v[20:23], v11 offset:1024
  ds_read_b128 v[24:27], v11 offset:2048
  ds_read_b128 v[28:31], v11 offset:3072
  ds_read_b128 v[32:35], v11 offset:4096
  ds_read_b128 v[36:39], v11 offset:5120
  ds_read_b128 v[40:43], v11 offset:6144
  ds_read_b128 v[44:47], v11 offset:7168
  ds_read_b128 v[48:51], v11 offset:8192
  ds_read_b128 v[52:55], v11 offset:9216
  ds_read_b128 v[56:59], v11 offset:10240
  ds_read_b128 v[60:63], v11 offset:11264
  s_waitcnt lgkmcnt(8)
  v_add_f32 v184, v184, v16
  v_add_f32 v185, v185, v17
  v_add_f32 v186, v186, v18
  v_add_f32 v187, v187, v19
  v_add_f32 v188, v188, v20
  v_add_f32 v189, v189, v21
  v_add_f32 v190, v190, v22
  v_add_f32 v191, v191, v23
  v_add_f32 v192, v192, v24
  v_add_f32 v193, v193, v25
  v_add_f32 v194, v194, v26
  v_add_f32 v195, v195, v27
  v_add_f32 v196, v196, v28
  v_add_f32 v197, v197, v29
  v_add_f32 v198, v198, v30
  v_add_f32 v199, v199, v31
  s_waitcnt lgkmcnt(4)
  v_add_f32 v184, v184, v32
  v_add_f32 v185, v185, v33
  v_add_f32 v186, v186, v34
  v_add_f32 v187, v187, v35
  v_add_f32 v188, v188, v36
  v_add_f32 v189, v189, v37
  v_add_f32 v190, v190, v38
  v_add_f32 v191, v191, v39
  v_add_f32 v192, v192, v40
  v_add_f32 v193, v193, v41
  v_add_f32 v194, v194, v42
  v_add_f32 v195, v195, v43
  v_add_f32 v196, v196, v44
  v_add_f32 v197, v197, v45
  v_add_f32 v198, v198, v46
  v_add_f32 v199, v199, v47
  s_waitcnt lgkmcnt(0)
  v_add_f32 v184, v184, v48
  v_add_f32 v185, v185, v49
  v_add_f32 v186, v186, v50
  v_add_f32 v187, v187, v51
  v_add_f32 v188, v188, v52
  v_add_f32 v189, v189, v53
  v_add_f32 v190, v190, v54
  v_add_f32 v191, v191, v55
  v_add_f32 v192, v192, v56
  v_add_f32 v193, v193, v57
  v_add_f32 v194, v194, v58
  v_add_f32 v195, v195, v59
  v_add_f32 v196, v196, v60
  v_add_f32 v197, v197, v61
  v_add_f32 v198, v198, v62
  v_add_f32 v199, v199, v63
  v_cvt_pk_bf16_f32 v112, v184, v185
  v_cvt_pk_bf16_f32 v113, v186, v187
  v_cvt_pk_bf16_f32 v114, v188, v189
  v_cvt_pk_bf16_f32 v115, v190, v191
  v_cvt_pk_bf16_f32 v116, v192, v193
  v_cvt_pk_bf16_f32 v117, v194, v195
  v_cvt_pk_bf16_f32 v118, v196, v197
  v_cvt_pk_bf16_f32 v119, v198, v199
  s_nop 1
  v_permlane32_swap_b32 v112, v114
  v_permlane32_swap_b32 v113, v115
  v_permlane32_swap_b32 v116, v118
  v_permlane32_swap_b32 v117, v119
  s_nop 1
  buffer_store_dwordx4 v[112:115], v7, s[20:23], s43 offen
  buffer_store_dwordx4 v[116:119], v7, s[20:23], s43 offen offset:32
K3_END:
  s_endpgm
CODE_END:
.section .rodata,"a"
.p2align 6
.amdhsa_kernel k1_kernel
  .amdhsa_next_free_vgpr 254
  .amdhsa_next_free_sgpr 80
  .amdhsa_accum_offset 256
  .amdhsa_group_segment_fixed_size 0
  .amdhsa_float_denorm_mode_32 3
  .amdhsa_kernarg_size 88
  .amdhsa_user_sgpr_count 2
  .amdhsa_user_sgpr_kernarg_segment_ptr 1
  .amdhsa_system_sgpr_workgroup_id_x 1
.end_amdhsa_kernel
.p2align 6
.amdhsa_kernel k2_kernel
  .amdhsa_next_free_vgpr 252
  .amdhsa_next_free_sgpr 68
  .amdhsa_accum_offset 252
  .amdhsa_group_segment_fixed_size 0
  .amdhsa_float_denorm_mode_32 3
  .amdhsa_kernarg_size 88
  .amdhsa_user_sgpr_count 2
  .amdhsa_user_sgpr_kernarg_segment_ptr 1
  .amdhsa_system_sgpr_workgroup_id_x 1
.end_amdhsa_kernel
.p2align 6
.amdhsa_kernel k3_kernel
  .amdhsa_next_free_vgpr 256
  .amdhsa_next_free_sgpr 56
  .amdhsa_accum_offset 256
  .amdhsa_group_segment_fixed_size 0
  .amdhsa_float_denorm_mode_32 3
  .amdhsa_kernarg_size 88
  .amdhsa_user_sgpr_count 2
  .amdhsa_user_sgpr_kernarg_segment_ptr 1
  .amdhsa_system_sgpr_workgroup_id_x 1
.end_amdhsa_kernel
```
